```python
import torch

def _softmax(x, axis=-1):
    return torch.softmax(x, dim=axis)
def _gelu(x):
    return torch.nn.functional.gelu(x, approximate="tanh")
def _silu(x):
    return torch.nn.functional.silu(x)
def _sigmoid(x):
    return torch.sigmoid(x)
def _layernorm(x, axis=-1, eps=1e-5):
    m = x.mean(dim=axis, keepdim=True)
    v = x.var(dim=axis, keepdim=True, unbiased=False)
    return (x - m) / torch.sqrt(v + eps)
def _scatter_add(tgt, idx, src, axis=0):
    return tgt.clone().index_add_(axis, idx, src)
def _segment_sum(src, seg, n):
    out = torch.zeros((n,) + src.shape[1:], dtype=src.dtype)
    return out.index_add_(0, seg, src)
def _pad(x, pw):
    flat = tuple(v for pair in reversed(pw) for v in pair)
    return torch.nn.functional.pad(x, flat)

kernel_name = 'recurrent_scan__mha_block_cached__dense_activation_squared_relu__decode'

def setup_inputs():

    _w = (lambda a: (lambda t: t.to(torch.bfloat16) if t.is_floating_point() else t)(torch.as_tensor(a)))
    def _A_setup():
        B, Sq, D = 4, 1, 448
        H, Sk, Dh = 16, 4096, 256
        return {
            "x": _w((lambda *s: torch.randn(*s, dtype=torch.bfloat16) * 0.05)(B, Sq, D)),
            "k_cache": _w((lambda *s: torch.randn(*s, dtype=torch.bfloat16) * 0.8)(B, H, Sk, Dh)),
            "v_cache": _w((lambda *s: torch.randn(*s, dtype=torch.bfloat16) * 0.2)(B, H, Sk, Dh)),
            "wq": _w((lambda *s: torch.randn(*s, dtype=torch.bfloat16) * 0.8)(D, H * Dh) * (D ** -0.5)),
            "wo": _w((lambda *s: torch.randn(*s, dtype=torch.bfloat16) * 0.2)(H * Dh, D) * ((H * Dh) ** -0.5)),
        }
    _A_in = _A_setup()

    def _B_setup():
        B, S, D, F = 4, 1, 448, 1792
        return {
            "x": _w((lambda *s: torch.randn(*s, dtype=torch.bfloat16) * 0.05)(B, S, D)),
            "w1": _w((lambda *s: torch.randn(*s, dtype=torch.bfloat16) * 0.1)(D, F)),
            "b1": _w((lambda *s: torch.randn(*s, dtype=torch.bfloat16) * 0.1)(F)),
            "w2": _w((lambda *s: torch.randn(*s, dtype=torch.bfloat16) * 0.1)(F, D)),
            "b2": _w((lambda *s: torch.randn(*s, dtype=torch.bfloat16) * 0.1)(D)),
        }
    _B_in = _B_setup()

    return {
        "A_x": _A_in["x"],
        "A_k_cache": _A_in["k_cache"],
        "A_v_cache": _A_in["v_cache"],
        "A_wq": _A_in["wq"],
        "A_wo": _A_in["wo"],
        "B_x": _B_in["x"],
        "B_w1": _B_in["w1"],
        "B_b1": _B_in["b1"],
        "B_w2": _B_in["w2"],
        "B_b2": _B_in["b2"],
    }

def reference(A_x, A_k_cache, A_v_cache, A_wq, A_wo, B_x, B_w1, B_b1, B_w2, B_b2):
    def _A_ref(x, k_cache, v_cache, wq, wo):
        B, Sq, D = x.shape
        H, Dh = 16, 256
        q = (lambda x, *d: x.permute(*d))((x @ wq).reshape(B, Sq, H, Dh), 0, 2, 1, 3)
        scores = torch.einsum("bhqd,bhkd->bhqk", q, k_cache) * (Dh ** -0.5)
        p = _softmax(scores, axis=-1)
        o = torch.einsum("bhqk,bhkd->bhqd", p, v_cache)
        return (lambda x, *d: x.permute(*d))(o, 0, 2, 1, 3).reshape(B, Sq, H * Dh) @ wo

    def _B_ref(x, w1, b1, w2, b2):
        h = torch.einsum("bsd,df->bsf", x, w1) + b1
        zero = torch.zeros_like(h)
        r = torch.where(h > zero, h, zero)
        h = r * r
        out = torch.einsum("bsf,fd->bsd", h, w2) + b2
        return out

    x = A_x
    xn = _layernorm(x, axis=-1)
    s = _A_ref(xn, A_k_cache, A_v_cache, A_wq, A_wo)
    g = _silu(_B_ref(xn, B_w1, B_b1, B_w2, B_b2))
    return x + s * g
```

```asm
; @launch grid=(256,1,1) block=(256,1,1) lds=162048
.amdgcn_target "amdgcn-amd-amdhsa--gfx950"
.text
    .globl recurrent_scan__mha_block_cached__dense_activation_squared_relu__decode_kernel
    .p2align 8
    .type recurrent_scan__mha_block_cached__dense_activation_squared_relu__decode_kernel,@function
recurrent_scan__mha_block_cached__dense_activation_squared_relu__decode_kernel:
    s_cmp_ge_u32 s2, 256
    s_cbranch_scc1 recurrent_scan__mha_block_cached__dense_activation_squared_relu__decode_kernel_end
    s_load_dwordx16 s[16:31], s[0:1], 0
    s_load_dwordx2 s[40:41], s[0:1], 96
    s_load_dwordx8 s[32:39], s[0:1], 64
    v_lshrrev_b32 v32, 6, v0
    v_and_b32 v1, 63, v0
    v_lshlrev_b32 v2, 4, v1
    v_readfirstlane_b32 s3, v32
    s_lshr_b32 s12, s2, 1
    s_xor_b32 s13, s2, s12
    s_and_b32 s13, s13, 1
    s_and_b32 s14, s12, 2
    s_or_b32 s13, s13, s14
    s_lshl_b32 s13, s13, 2
    s_bfe_u32 s14, s2, 0x20003
    s_or_b32 s13, s13, s14
    s_bfe_u32 s14, s2, 0x20005
    s_lshr_b32 s15, s2, 7
    s_lshl_b32 s15, s15, 1
    s_and_b32 s12, s12, 1
    s_or_b32 s15, s15, s12
    v_add_u32 v3, 0x1000, v2
    v_mov_b32 v236, 0
    s_lshl_b32 s47, s14, 2
    s_add_u32 s47, s47, s15
    s_lshl_b32 s97, s14, 4
    s_add_u32 s97, s97, s13
    s_mov_b32 s47, s15
    s_lshl_b32 s55, s47, 2
    s_add_u32 s55, s55, s3
    s_mov_b32 s100, s55
    s_mul_i32 s48, s97, 2
    s_lshl_b32 s12, s97, 21
    s_lshl_b32 s8, s3, 15
    s_mul_i32 s50, s3, 7168
    s_add_u32 s50, s50, 131072
    s_lshl_b32 s43, s14, 4
    s_add_u32 s43, s43, s13
    s_mov_b32 s9, 0
    v_lshrrev_b32 v208, 4, v1
    v_and_b32 v209, 15, v1
    s_cmp_eq_u32 s15, 0
    s_cselect_b32 s54, 1, 0
    s_cmp_lg_u32 s15, 3
    s_cbranch_scc1 recurrent_scan__mha_block_cached__dense_activation_squared_relu__decode_kernel_rset
    s_cmp_lt_u32 s43, 56
    s_cselect_b32 s54, 2, 0
recurrent_scan__mha_block_cached__dense_activation_squared_relu__decode_kernel_rset:
    s_cmp_lg_u32 s54, 0
    s_cbranch_scc1 recurrent_scan__mha_block_cached__dense_activation_squared_relu__decode_kernel_role
    s_waitcnt lgkmcnt(0)
    s_load_dword s49, s[40:41], 0
    s_add_u32 s18, s18, s12
    s_addc_u32 s19, s19, 0
    s_add_u32 s20, s20, s12
    s_addc_u32 s21, s21, 0
    s_add_u32 s6, s55, s48
    s_and_b32 s6, s6, 0x7f
    s_lshl_b32 s6, s6, 14
    s_add_u32 s4, s18, s6
    s_addc_u32 s5, s19, 0
    s_add_u32 s6, s4, 0x2000
    s_addc_u32 s7, s5, 0
    s_add_u32 s55, s55, 16
    global_load_dwordx4 v[48:51], v2, s[4:5] offset:0 nt
    global_load_dwordx4 v[52:55], v2, s[4:5] offset:1024 nt
    global_load_dwordx4 v[56:59], v2, s[4:5] offset:2048 nt
    global_load_dwordx4 v[60:63], v2, s[4:5] offset:3072 nt
    global_load_dwordx4 v[64:67], v3, s[4:5] offset:0 nt
    global_load_dwordx4 v[68:71], v3, s[4:5] offset:1024 nt
    global_load_dwordx4 v[72:75], v3, s[4:5] offset:2048 nt
    global_load_dwordx4 v[76:79], v3, s[4:5] offset:3072 nt
    s_branch recurrent_scan__mha_block_cached__dense_activation_squared_relu__decode_kernel_stream0
recurrent_scan__mha_block_cached__dense_activation_squared_relu__decode_kernel_role:
    v_mul_u32_u24 v210, 896, v208
    v_mul_u32_u24 v211, 56, v209
    v_add_u32 v210, v210, v211
    s_mul_i32 s45, s3, 224
    v_and_b32 v214, 3, v1
    v_mul_u32_u24 v211, 896, v214
    v_lshl_add_u32 v211, v208, 3, v211
    v_add_u32 v211, s45, v211
    v_lshlrev_b32 v214, 6, v214
    s_add_u32 m0, s8, 0x4000
    s_cmp_eq_u32 s54, 2
    s_cbranch_scc1 recurrent_scan__mha_block_cached__dense_activation_squared_relu__decode_kernel_ffn
    s_mul_i32 s45, s3, 917504
    s_lshl_b32 s46, s13, 9
    s_add_u32 s45, s45, s46
    s_lshl_b32 s46, s14, 7
    s_add_u32 s45, s45, s46
    v_lshrrev_b32 v212, 3, v1
    v_lshlrev_b32 v212, 13, v212
    v_and_b32 v213, 7, v1
    v_lshl_add_u32 v212, v213, 4, v212
    v_add_u32 v212, s45, v212
    s_mov_b32 s45, 0x10000
    v_lshrrev_b32 v213, 2, v1
    v_lshlrev_b32 v213, 7, v213
    v_and_b32 v219, 3, v1
    v_lshl_add_u32 v213, v219, 3, v213
    s_add_u32 s46, s8, 0x4000
    v_add_u32 v213, s46, v213
    s_waitcnt lgkmcnt(0)
    s_or_b32 s46, s43, s3
    s_cbranch_scc1 recurrent_scan__mha_block_cached__dense_activation_squared_relu__decode_kernel_noand
    v_mov_b32 v37, 0xffffff00
    s_mov_b64 exec, 1
    global_atomic_and v236, v37, s[40:41] sc1
    s_mov_b64 exec, -1
recurrent_scan__mha_block_cached__dense_activation_squared_relu__decode_kernel_noand:
    global_load_dwordx4 v[126:129], v210, s[16:17] offset:0
    global_load_dwordx4 v[130:133], v210, s[16:17] offset:16
    global_load_dwordx4 v[134:137], v210, s[16:17] offset:32
    global_load_dwordx2 v[138:139], v210, s[16:17] offset:48
    global_load_dwordx2 v[112:113], v211, s[16:17] offset:0
    global_load_dwordx2 v[114:115], v211, s[16:17] offset:32
    global_load_dwordx2 v[116:117], v211, s[16:17] offset:64
    global_load_dwordx2 v[118:119], v211, s[16:17] offset:96
    global_load_dwordx2 v[120:121], v211, s[16:17] offset:128
    global_load_dwordx2 v[122:123], v211, s[16:17] offset:160
    global_load_dwordx2 v[124:125], v211, s[16:17] offset:192
    global_load_lds_dwordx4 v212, s[22:23] nt
    s_add_u32 m0, m0, 0x400
    v_add_u32 v212, s45, v212
    global_load_lds_dwordx4 v212, s[22:23] nt
    s_add_u32 m0, m0, 0x400
    v_add_u32 v212, s45, v212
    global_load_lds_dwordx4 v212, s[22:23] nt
    s_add_u32 m0, m0, 0x400
    v_add_u32 v212, s45, v212
    global_load_lds_dwordx4 v212, s[22:23] nt
    s_add_u32 m0, m0, 0x400
    v_add_u32 v212, s45, v212
    global_load_lds_dwordx4 v212, s[22:23] nt
    s_add_u32 m0, m0, 0x400
    v_add_u32 v212, s45, v212
    global_load_lds_dwordx4 v212, s[22:23] nt
    s_add_u32 m0, m0, 0x400
    v_add_u32 v212, s45, v212
    global_load_lds_dwordx4 v212, s[22:23] nt
    s_add_u32 m0, m0, 0x400
    v_add_u32 v212, s45, v212
    global_load_lds_dwordx4 v212, s[22:23] nt
    s_add_u32 m0, m0, 0x400
    v_add_u32 v212, s45, v212
    global_load_lds_dwordx4 v212, s[22:23] nt
    s_add_u32 m0, m0, 0x400
    v_add_u32 v212, s45, v212
    global_load_lds_dwordx4 v212, s[22:23] nt
    s_add_u32 m0, m0, 0x400
    v_add_u32 v212, s45, v212
    global_load_lds_dwordx4 v212, s[22:23] nt
    s_add_u32 m0, m0, 0x400
    v_add_u32 v212, s45, v212
    global_load_lds_dwordx4 v212, s[22:23] nt
    s_add_u32 m0, m0, 0x400
    v_add_u32 v212, s45, v212
    global_load_lds_dwordx4 v212, s[22:23] nt
    s_add_u32 m0, m0, 0x400
    v_add_u32 v212, s45, v212
    global_load_lds_dwordx4 v212, s[22:23] nt
    s_load_dword s49, s[40:41], 0
    s_add_u32 s18, s18, s12
    s_addc_u32 s19, s19, 0
    s_add_u32 s20, s20, s12
    s_addc_u32 s21, s21, 0
    s_add_u32 s6, s55, s48
    s_and_b32 s6, s6, 0x7f
    s_lshl_b32 s6, s6, 14
    s_add_u32 s4, s18, s6
    s_addc_u32 s5, s19, 0
    s_add_u32 s6, s4, 0x2000
    s_addc_u32 s7, s5, 0
    s_add_u32 s55, s55, 16
    global_load_dwordx4 v[48:51], v2, s[4:5] offset:0 nt
    global_load_dwordx4 v[52:55], v2, s[4:5] offset:1024 nt
    global_load_dwordx4 v[56:59], v2, s[4:5] offset:2048 nt
    global_load_dwordx4 v[60:63], v2, s[4:5] offset:3072 nt
    v_add_u32 v216, s50, v2
    s_lshl_b32 s45, s3, 9
    s_add_u32 s45, s45, 131072
    v_lshlrev_b32 v218, 4, v209
    v_add_u32 v218, s45, v218
    v_lshl_add_u32 v217, v208, 2, v218
    s_lshl_b32 s45, s13, 12
    s_lshl_b32 s46, s14, 8
    s_add_u32 s45, s45, s46
    s_lshl_b32 s46, s3, 6
    s_add_u32 s45, s45, s46
    s_add_u32 s45, s45, 4096
    v_lshlrev_b32 v210, 10, v208
    v_lshl_add_u32 v210, v209, 2, v210
    v_add_u32 v210, s45, v210
    s_lshl_b32 s45, s97, 8
    s_add_u32 s45, s45, 196608
    v_mov_b32 v212, s45
    s_waitcnt vmcnt(25)
    v_lshlrev_b32 v80, 16, v126
    v_and_b32 v81, 0xffff0000, v126
    v_lshlrev_b32 v82, 16, v127
    v_and_b32 v83, 0xffff0000, v127
    v_lshlrev_b32 v84, 16, v128
    v_and_b32 v85, 0xffff0000, v128
    v_lshlrev_b32 v86, 16, v129
    v_and_b32 v87, 0xffff0000, v129
    v_lshlrev_b32 v88, 16, v130
    v_and_b32 v89, 0xffff0000, v130
    v_lshlrev_b32 v90, 16, v131
    v_and_b32 v91, 0xffff0000, v131
    v_lshlrev_b32 v92, 16, v132
    v_and_b32 v93, 0xffff0000, v132
    v_lshlrev_b32 v94, 16, v133
    v_and_b32 v95, 0xffff0000, v133
    v_lshlrev_b32 v96, 16, v134
    v_and_b32 v97, 0xffff0000, v134
    v_lshlrev_b32 v98, 16, v135
    v_and_b32 v99, 0xffff0000, v135
    v_lshlrev_b32 v100, 16, v136
    v_and_b32 v101, 0xffff0000, v136
    v_lshlrev_b32 v102, 16, v137
    v_and_b32 v103, 0xffff0000, v137
    v_lshlrev_b32 v104, 16, v138
    v_and_b32 v105, 0xffff0000, v138
    v_lshlrev_b32 v106, 16, v139
    v_and_b32 v107, 0xffff0000, v139
    v_add_f32 v220, v80, v81
    v_add_f32 v221, v82, v83
    v_add_f32 v220, v220, v84
    v_add_f32 v221, v221, v85
    v_add_f32 v220, v220, v86
    v_add_f32 v221, v221, v87
    v_add_f32 v220, v220, v88
    v_add_f32 v221, v221, v89
    v_add_f32 v220, v220, v90
    v_add_f32 v221, v221, v91
    v_add_f32 v220, v220, v92
    v_add_f32 v221, v221, v93
    v_add_f32 v220, v220, v94
    v_add_f32 v221, v221, v95
    v_add_f32 v220, v220, v96
    v_add_f32 v221, v221, v97
    v_add_f32 v220, v220, v98
    v_add_f32 v221, v221, v99
    v_add_f32 v220, v220, v100
    v_add_f32 v221, v221, v101
    v_add_f32 v220, v220, v102
    v_add_f32 v221, v221, v103
    v_add_f32 v220, v220, v104
    v_add_f32 v221, v221, v105
    v_add_f32 v220, v220, v106
    v_add_f32 v221, v221, v107
    v_add_f32 v220, v220, v221
    s_nop 1
    v_add_f32_dpp v220, v220, v220 row_ror:8 row_mask:0xf bank_mask:0xf
    s_nop 1
    v_add_f32_dpp v220, v220, v220 row_ror:4 row_mask:0xf bank_mask:0xf
    s_nop 1
    v_add_f32_dpp v220, v220, v220 row_ror:2 row_mask:0xf bank_mask:0xf
    s_nop 1
    v_add_f32_dpp v220, v220, v220 row_ror:1 row_mask:0xf bank_mask:0xf
    v_mul_f32 v220, 0x3b124925, v220
    v_sub_f32 v80, v80, v220
    v_sub_f32 v81, v81, v220
    v_sub_f32 v82, v82, v220
    v_sub_f32 v83, v83, v220
    v_sub_f32 v84, v84, v220
    v_sub_f32 v85, v85, v220
    v_sub_f32 v86, v86, v220
    v_sub_f32 v87, v87, v220
    v_sub_f32 v88, v88, v220
    v_sub_f32 v89, v89, v220
    v_sub_f32 v90, v90, v220
    v_sub_f32 v91, v91, v220
    v_sub_f32 v92, v92, v220
    v_sub_f32 v93, v93, v220
    v_sub_f32 v94, v94, v220
    v_sub_f32 v95, v95, v220
    v_sub_f32 v96, v96, v220
    v_sub_f32 v97, v97, v220
    v_sub_f32 v98, v98, v220
    v_sub_f32 v99, v99, v220
    v_sub_f32 v100, v100, v220
    v_sub_f32 v101, v101, v220
    v_sub_f32 v102, v102, v220
    v_sub_f32 v103, v103, v220
    v_sub_f32 v104, v104, v220
    v_sub_f32 v105, v105, v220
    v_sub_f32 v106, v106, v220
    v_sub_f32 v107, v107, v220
    v_mul_f32 v221, v80, v80
    v_mul_f32 v222, v81, v81
    v_fmac_f32 v221, v82, v82
    v_fmac_f32 v222, v83, v83
    v_fmac_f32 v221, v84, v84
    v_fmac_f32 v222, v85, v85
    v_fmac_f32 v221, v86, v86
    v_fmac_f32 v222, v87, v87
    v_fmac_f32 v221, v88, v88
    v_fmac_f32 v222, v89, v89
    v_fmac_f32 v221, v90, v90
    v_fmac_f32 v222, v91, v91
    v_fmac_f32 v221, v92, v92
    v_fmac_f32 v222, v93, v93
    v_fmac_f32 v221, v94, v94
    v_fmac_f32 v222, v95, v95
    v_fmac_f32 v221, v96, v96
    v_fmac_f32 v222, v97, v97
    v_fmac_f32 v221, v98, v98
    v_fmac_f32 v222, v99, v99
    v_fmac_f32 v221, v100, v100
    v_fmac_f32 v222, v101, v101
    v_fmac_f32 v221, v102, v102
    v_fmac_f32 v222, v103, v103
    v_fmac_f32 v221, v104, v104
    v_fmac_f32 v222, v105, v105
    v_fmac_f32 v221, v106, v106
    v_fmac_f32 v222, v107, v107
    v_add_f32 v221, v221, v222
    s_nop 1
    v_add_f32_dpp v221, v221, v221 row_ror:8 row_mask:0xf bank_mask:0xf
    s_nop 1
    v_add_f32_dpp v221, v221, v221 row_ror:4 row_mask:0xf bank_mask:0xf
    s_nop 1
    v_add_f32_dpp v221, v221, v221 row_ror:2 row_mask:0xf bank_mask:0xf
    s_nop 1
    v_add_f32_dpp v221, v221, v221 row_ror:1 row_mask:0xf bank_mask:0xf
    v_mul_f32 v221, 0x3b124925, v221
    v_cvt_pk_bf16_f32 v221, v221, v220
    v_and_b32 v224, 0xffff0000, v221
    v_lshlrev_b32 v221, 16, v221
    v_add_f32 v221, 0x3727c5ac, v221
    v_cvt_pk_bf16_f32 v221, v221, v221
    v_lshlrev_b32 v221, 16, v221
    v_sqrt_f32 v221, v221
    s_nop 0
    v_cvt_pk_bf16_f32 v221, v221, v221
    v_lshlrev_b32 v221, 16, v221
    v_rcp_f32 v225, v221
    ds_bpermute_b32 v224, v214, v224
    ds_bpermute_b32 v225, v214, v225
    s_waitcnt vmcnt(18)
    v_lshlrev_b32 v80, 16, v112
    v_and_b32 v81, 0xffff0000, v112
    v_lshlrev_b32 v82, 16, v113
    v_and_b32 v83, 0xffff0000, v113
    v_lshlrev_b32 v84, 16, v114
    v_and_b32 v85, 0xffff0000, v114
    v_lshlrev_b32 v86, 16, v115
    v_and_b32 v87, 0xffff0000, v115
    v_lshlrev_b32 v88, 16, v116
    v_and_b32 v89, 0xffff0000, v116
    v_lshlrev_b32 v90, 16, v117
    v_and_b32 v91, 0xffff0000, v117
    v_lshlrev_b32 v92, 16, v118
    v_and_b32 v93, 0xffff0000, v118
    v_lshlrev_b32 v94, 16, v119
    v_and_b32 v95, 0xffff0000, v119
    v_lshlrev_b32 v96, 16, v120
    v_and_b32 v97, 0xffff0000, v120
    v_lshlrev_b32 v98, 16, v121
    v_and_b32 v99, 0xffff0000, v121
    v_lshlrev_b32 v100, 16, v122
    v_and_b32 v101, 0xffff0000, v122
    v_lshlrev_b32 v102, 16, v123
    v_and_b32 v103, 0xffff0000, v123
    v_lshlrev_b32 v104, 16, v124
    v_and_b32 v105, 0xffff0000, v124
    v_lshlrev_b32 v106, 16, v125
    v_and_b32 v107, 0xffff0000, v125
    s_waitcnt lgkmcnt(0)
    v_sub_f32 v80, v80, v224
    v_sub_f32 v81, v81, v224
    v_sub_f32 v82, v82, v224
    v_sub_f32 v83, v83, v224
    v_sub_f32 v84, v84, v224
    v_sub_f32 v85, v85, v224
    v_sub_f32 v86, v86, v224
    v_sub_f32 v87, v87, v224
    v_sub_f32 v88, v88, v224
    v_sub_f32 v89, v89, v224
    v_sub_f32 v90, v90, v224
    v_sub_f32 v91, v91, v224
    v_sub_f32 v92, v92, v224
    v_sub_f32 v93, v93, v224
    v_sub_f32 v94, v94, v224
    v_sub_f32 v95, v95, v224
    v_sub_f32 v96, v96, v224
    v_sub_f32 v97, v97, v224
    v_sub_f32 v98, v98, v224
    v_sub_f32 v99, v99, v224
    v_sub_f32 v100, v100, v224
    v_sub_f32 v101, v101, v224
    v_sub_f32 v102, v102, v224
    v_sub_f32 v103, v103, v224
    v_sub_f32 v104, v104, v224
    v_sub_f32 v105, v105, v224
    v_sub_f32 v106, v106, v224
    v_sub_f32 v107, v107, v224
    v_cvt_pk_bf16_f32 v112, v80, v81
    v_cvt_pk_bf16_f32 v113, v82, v83
    v_cvt_pk_bf16_f32 v114, v84, v85
    v_cvt_pk_bf16_f32 v115, v86, v87
    v_cvt_pk_bf16_f32 v116, v88, v89
    v_cvt_pk_bf16_f32 v117, v90, v91
    v_cvt_pk_bf16_f32 v118, v92, v93
    v_cvt_pk_bf16_f32 v119, v94, v95
    v_cvt_pk_bf16_f32 v120, v96, v97
    v_cvt_pk_bf16_f32 v121, v98, v99
    v_cvt_pk_bf16_f32 v122, v100, v101
    v_cvt_pk_bf16_f32 v123, v102, v103
    v_cvt_pk_bf16_f32 v124, v104, v105
    v_cvt_pk_bf16_f32 v125, v106, v107
    v_lshlrev_b32 v80, 16, v112
    v_and_b32 v81, 0xffff0000, v112
    v_lshlrev_b32 v82, 16, v113
    v_and_b32 v83, 0xffff0000, v113
    v_lshlrev_b32 v84, 16, v114
    v_and_b32 v85, 0xffff0000, v114
    v_lshlrev_b32 v86, 16, v115
    v_and_b32 v87, 0xffff0000, v115
    v_lshlrev_b32 v88, 16, v116
    v_and_b32 v89, 0xffff0000, v116
    v_lshlrev_b32 v90, 16, v117
    v_and_b32 v91, 0xffff0000, v117
    v_lshlrev_b32 v92, 16, v118
    v_and_b32 v93, 0xffff0000, v118
    v_lshlrev_b32 v94, 16, v119
    v_and_b32 v95, 0xffff0000, v119
    v_lshlrev_b32 v96, 16, v120
    v_and_b32 v97, 0xffff0000, v120
    v_lshlrev_b32 v98, 16, v121
    v_and_b32 v99, 0xffff0000, v121
    v_lshlrev_b32 v100, 16, v122
    v_and_b32 v101, 0xffff0000, v122
    v_lshlrev_b32 v102, 16, v123
    v_and_b32 v103, 0xffff0000, v123
    v_lshlrev_b32 v104, 16, v124
    v_and_b32 v105, 0xffff0000, v124
    v_lshlrev_b32 v106, 16, v125
    v_and_b32 v107, 0xffff0000, v125
    v_mul_f32 v80, v80, v225
    v_mul_f32 v81, v81, v225
    v_mul_f32 v82, v82, v225
    v_mul_f32 v83, v83, v225
    v_mul_f32 v84, v84, v225
    v_mul_f32 v85, v85, v225
    v_mul_f32 v86, v86, v225
    v_mul_f32 v87, v87, v225
    v_mul_f32 v88, v88, v225
    v_mul_f32 v89, v89, v225
    v_mul_f32 v90, v90, v225
    v_mul_f32 v91, v91, v225
    v_mul_f32 v92, v92, v225
    v_mul_f32 v93, v93, v225
    v_mul_f32 v94, v94, v225
    v_mul_f32 v95, v95, v225
    v_mul_f32 v96, v96, v225
    v_mul_f32 v97, v97, v225
    v_mul_f32 v98, v98, v225
    v_mul_f32 v99, v99, v225
    v_mul_f32 v100, v100, v225
    v_mul_f32 v101, v101, v225
    v_mul_f32 v102, v102, v225
    v_mul_f32 v103, v103, v225
    v_mul_f32 v104, v104, v225
    v_mul_f32 v105, v105, v225
    v_mul_f32 v106, v106, v225
    v_mul_f32 v107, v107, v225
    v_cvt_pk_bf16_f32 v112, v80, v81
    v_cvt_pk_bf16_f32 v113, v82, v83
    v_cvt_pk_bf16_f32 v114, v84, v85
    v_cvt_pk_bf16_f32 v115, v86, v87
    v_cvt_pk_bf16_f32 v116, v88, v89
    v_cvt_pk_bf16_f32 v117, v90, v91
    v_cvt_pk_bf16_f32 v118, v92, v93
    v_cvt_pk_bf16_f32 v119, v94, v95
    v_cvt_pk_bf16_f32 v120, v96, v97
    v_cvt_pk_bf16_f32 v121, v98, v99
    v_cvt_pk_bf16_f32 v122, v100, v101
    v_cvt_pk_bf16_f32 v123, v102, v103
    v_cvt_pk_bf16_f32 v124, v104, v105
    v_cvt_pk_bf16_f32 v125, v106, v107
    s_waitcnt vmcnt(4)
    ds_read_b64_tr_b16 v[140:141], v213 offset:0
    ds_read_b64_tr_b16 v[142:143], v213 offset:32
    ds_read_b64_tr_b16 v[144:145], v213 offset:64
    ds_read_b64_tr_b16 v[146:147], v213 offset:96
    ds_read_b64_tr_b16 v[148:149], v213 offset:2048
    ds_read_b64_tr_b16 v[150:151], v213 offset:2080
    ds_read_b64_tr_b16 v[152:153], v213 offset:2112
    ds_read_b64_tr_b16 v[154:155], v213 offset:2144
    ds_read_b64_tr_b16 v[156:157], v213 offset:4096
    ds_read_b64_tr_b16 v[158:159], v213 offset:4128
    ds_read_b64_tr_b16 v[160:161], v213 offset:4160
    ds_read_b64_tr_b16 v[162:163], v213 offset:4192
    ds_read_b64_tr_b16 v[164:165], v213 offset:6144
    ds_read_b64_tr_b16 v[166:167], v213 offset:6176
    ds_read_b64_tr_b16 v[168:169], v213 offset:6208
    ds_read_b64_tr_b16 v[170:171], v213 offset:6240
    ds_read_b64_tr_b16 v[172:173], v213 offset:8192
    ds_read_b64_tr_b16 v[174:175], v213 offset:8224
    ds_read_b64_tr_b16 v[176:177], v213 offset:8256
    ds_read_b64_tr_b16 v[178:179], v213 offset:8288
    ds_read_b64_tr_b16 v[180:181], v213 offset:10240
    ds_read_b64_tr_b16 v[182:183], v213 offset:10272
    ds_read_b64_tr_b16 v[184:185], v213 offset:10304
    ds_read_b64_tr_b16 v[186:187], v213 offset:10336
    ds_read_b64_tr_b16 v[188:189], v213 offset:12288
    ds_read_b64_tr_b16 v[190:191], v213 offset:12320
    ds_read_b64_tr_b16 v[192:193], v213 offset:12352
    ds_read_b64_tr_b16 v[194:195], v213 offset:12384
    s_waitcnt lgkmcnt(15)
    v_mfma_f32_16x16x16_bf16 v[80:83], v[112:113], v[140:141], 0
    v_mfma_f32_16x16x16_bf16 v[84:87], v[112:113], v[142:143], 0
    v_mfma_f32_16x16x16_bf16 v[88:91], v[112:113], v[144:145], 0
    v_mfma_f32_16x16x16_bf16 v[92:95], v[112:113], v[146:147], 0
    s_waitcnt lgkmcnt(15)
    v_mfma_f32_16x16x16_bf16 v[80:83], v[114:115], v[148:149], v[80:83]
    v_mfma_f32_16x16x16_bf16 v[84:87], v[114:115], v[150:151], v[84:87]
    v_mfma_f32_16x16x16_bf16 v[88:91], v[114:115], v[152:153], v[88:91]
    v_mfma_f32_16x16x16_bf16 v[92:95], v[114:115], v[154:155], v[92:95]
    s_waitcnt lgkmcnt(15)
    v_mfma_f32_16x16x16_bf16 v[80:83], v[116:117], v[156:157], v[80:83]
    v_mfma_f32_16x16x16_bf16 v[84:87], v[116:117], v[158:159], v[84:87]
    v_mfma_f32_16x16x16_bf16 v[88:91], v[116:117], v[160:161], v[88:91]
    v_mfma_f32_16x16x16_bf16 v[92:95], v[116:117], v[162:163], v[92:95]
    s_waitcnt lgkmcnt(12)
    v_mfma_f32_16x16x16_bf16 v[80:83], v[118:119], v[164:165], v[80:83]
    v_mfma_f32_16x16x16_bf16 v[84:87], v[118:119], v[166:167], v[84:87]
    v_mfma_f32_16x16x16_bf16 v[88:91], v[118:119], v[168:169], v[88:91]
    v_mfma_f32_16x16x16_bf16 v[92:95], v[118:119], v[170:171], v[92:95]
    s_waitcnt lgkmcnt(8)
    v_mfma_f32_16x16x16_bf16 v[80:83], v[120:121], v[172:173], v[80:83]
    v_mfma_f32_16x16x16_bf16 v[84:87], v[120:121], v[174:175], v[84:87]
    v_mfma_f32_16x16x16_bf16 v[88:91], v[120:121], v[176:177], v[88:91]
    v_mfma_f32_16x16x16_bf16 v[92:95], v[120:121], v[178:179], v[92:95]
    s_waitcnt lgkmcnt(4)
    v_mfma_f32_16x16x16_bf16 v[80:83], v[122:123], v[180:181], v[80:83]
    v_mfma_f32_16x16x16_bf16 v[84:87], v[122:123], v[182:183], v[84:87]
    v_mfma_f32_16x16x16_bf16 v[88:91], v[122:123], v[184:185], v[88:91]
    v_mfma_f32_16x16x16_bf16 v[92:95], v[122:123], v[186:187], v[92:95]
    s_waitcnt lgkmcnt(0)
    v_mfma_f32_16x16x16_bf16 v[80:83], v[124:125], v[188:189], v[80:83]
    v_mfma_f32_16x16x16_bf16 v[84:87], v[124:125], v[190:191], v[84:87]
    v_mfma_f32_16x16x16_bf16 v[88:91], v[124:125], v[192:193], v[88:91]
    v_mfma_f32_16x16x16_bf16 v[92:95], v[124:125], v[194:195], v[92:95]
    s_mov_b64 exec, 0xffff
    s_nop 3
    ds_write_b128 v216, v[80:83] offset:0
    ds_write_b128 v216, v[84:87] offset:512
    ds_write_b128 v216, v[88:91] offset:1024
    ds_write_b128 v216, v[92:95] offset:1536
    s_mov_b64 exec, -1
    s_waitcnt lgkmcnt(0)
    s_barrier
    ds_read_b32 v32, v217 offset:0
    ds_read_b32 v33, v217 offset:7168
    ds_read_b32 v34, v217 offset:14336
    ds_read_b32 v35, v217 offset:21504
    s_lshr_b32 s45, s49, 8
    s_add_u32 s45, s45, 1
    s_or_b32 s45, s45, 0x80000000
    v_mov_b32 v219, s45
    s_or_b32 s46, s3, s3
    s_waitcnt lgkmcnt(0)
    v_add_f32 v32, v32, v33
    v_add_f32 v34, v34, v35
    v_add_f32 v32, v32, v34
    v_mov_b32 v35, v219
    v_lshlrev_b32 v36, 12, v219
    v_mov_b32_dpp v33, v32 quad_perm:[1,0,3,2] row_mask:0xf bank_mask:0xf
    v_cvt_pk_bf16_f32 v34, v32, v33
    s_mov_b32 exec_lo, 0x55555555
    s_mov_b32 exec_hi, 0x55555555
    global_store_dwordx2 v210, v[34:35], s[40:41] sc1
    s_mov_b64 exec, 1
    s_cmp_lg_u32 s46, 0
    s_cbranch_scc1 recurrent_scan__mha_block_cached__dense_activation_squared_relu__decode_kernel_noinit
    global_store_dword v212, v36, s[40:41] sc1
recurrent_scan__mha_block_cached__dense_activation_squared_relu__decode_kernel_noinit:
    s_mov_b64 exec, -1
    global_load_dwordx4 v[64:67], v3, s[4:5] offset:0 nt
    global_load_dwordx4 v[68:71], v3, s[4:5] offset:1024 nt
    global_load_dwordx4 v[72:75], v3, s[4:5] offset:2048 nt
    global_load_dwordx4 v[76:79], v3, s[4:5] offset:3072 nt
    s_branch recurrent_scan__mha_block_cached__dense_activation_squared_relu__decode_kernel_stream0
recurrent_scan__mha_block_cached__dense_activation_squared_relu__decode_kernel_ffn:
    s_mul_i32 s45, s3, 401408
    s_lshl_b32 s46, s43, 6
    s_add_u32 s45, s45, s46
    v_lshrrev_b32 v212, 2, v1
    v_mul_u32_u24 v212, 3584, v212
    v_and_b32 v213, 3, v1
    v_lshl_add_u32 v212, v213, 4, v212
    v_add_u32 v212, s45, v212
    s_mul_i32 s45, s43, 28672
    s_mul_i32 s46, s3, 224
    s_add_u32 s45, s45, s46
    v_add_u32 v140, 0, v1
    v_mul_u32_u24 v216, 4682, v140
    v_lshrrev_b32 v216, 16, v216
    v_mul_u32_u24 v216, 672, v216
    v_lshl_add_u32 v140, v140, 4, v216
    v_add_u32 v140, s45, v140
    v_add_u32 v141, 64, v1
    v_mul_u32_u24 v216, 4682, v141
    v_lshrrev_b32 v216, 16, v216
    v_mul_u32_u24 v216, 672, v216
    v_lshl_add_u32 v141, v141, 4, v216
    v_add_u32 v141, s45, v141
    v_add_u32 v142, 128, v1
    v_mul_u32_u24 v216, 4682, v142
    v_lshrrev_b32 v216, 16, v216
    v_mul_u32_u24 v216, 672, v216
    v_lshl_add_u32 v142, v142, 4, v216
    v_add_u32 v142, s45, v142
    v_add_u32 v143, 192, v1
    v_mul_u32_u24 v216, 4682, v143
    v_lshrrev_b32 v216, 16, v216
    v_mul_u32_u24 v216, 672, v216
    v_lshl_add_u32 v143, v143, 4, v216
    v_add_u32 v143, s45, v143
    v_add_u32 v144, 256, v1
    v_mul_u32_u24 v216, 4682, v144
    v_lshrrev_b32 v216, 16, v216
    v_mul_u32_u24 v216, 672, v216
    v_lshl_add_u32 v144, v144, 4, v216
    v_add_u32 v144, s45, v144
    v_add_u32 v145, 320, v1
    v_mul_u32_u24 v216, 4682, v145
    v_lshrrev_b32 v216, 16, v216
    v_mul_u32_u24 v216, 672, v216
    v_lshl_add_u32 v145, v145, 4, v216
    v_add_u32 v145, s45, v145
    v_add_u32 v146, 384, v1
    v_mul_u32_u24 v216, 4682, v146
    v_lshrrev_b32 v216, 16, v216
    v_mul_u32_u24 v216, 672, v216
    v_lshl_add_u32 v146, v146, 4, v216
    v_add_u32 v146, s45, v146
    s_mov_b32 s45, 57344
    s_lshl_b32 s46, s43, 6
    v_lshlrev_b32 v215, 2, v209
    v_add_u32 v215, s46, v215
    s_waitcnt lgkmcnt(0)
    s_load_dword s49, s[40:41], 0
    s_add_u32 s18, s18, s12
    s_addc_u32 s19, s19, 0
    s_add_u32 s20, s20, s12
    s_addc_u32 s21, s21, 0
    s_add_u32 s6, s55, s48
    s_and_b32 s6, s6, 0x7f
    s_lshl_b32 s6, s6, 14
    s_add_u32 s4, s18, s6
    s_addc_u32 s5, s19, 0
    s_add_u32 s6, s4, 0x2000
    s_addc_u32 s7, s5, 0
    s_add_u32 s55, s55, 16
    global_load_dwordx4 v[48:51], v2, s[4:5] offset:0 nt
    global_load_dwordx4 v[52:55], v2, s[4:5] offset:1024 nt
    global_load_dwordx4 v[56:59], v2, s[4:5] offset:2048 nt
    global_load_dwordx4 v[60:63], v2, s[4:5] offset:3072 nt
    global_load_dwordx4 v[64:67], v3, s[4:5] offset:0 nt
    global_load_dwordx4 v[68:71], v3, s[4:5] offset:1024 nt
    global_load_dwordx4 v[72:75], v3, s[4:5] offset:2048 nt
    global_load_dwordx4 v[76:79], v3, s[4:5] offset:3072 nt
    global_load_dwordx4 v[126:129], v210, s[16:17] offset:0
    global_load_dwordx4 v[130:133], v210, s[16:17] offset:16
    global_load_dwordx4 v[134:137], v210, s[16:17] offset:32
    global_load_dwordx2 v[138:139], v210, s[16:17] offset:48
    global_load_dwordx2 v[112:113], v211, s[16:17] offset:0
    global_load_dwordx2 v[114:115], v211, s[16:17] offset:32
    global_load_dwordx2 v[116:117], v211, s[16:17] offset:64
    global_load_dwordx2 v[118:119], v211, s[16:17] offset:96
    global_load_dwordx2 v[120:121], v211, s[16:17] offset:128
    global_load_dwordx2 v[122:123], v211, s[16:17] offset:160
    global_load_dwordx2 v[124:125], v211, s[16:17] offset:192
    global_load_lds_dwordx4 v140, s[32:33] nt
    s_add_u32 m0, m0, 0x400
    s_nop 0
    global_load_lds_dwordx4 v141, s[32:33] nt
    s_add_u32 m0, m0, 0x400
    s_nop 0
    global_load_lds_dwordx4 v142, s[32:33] nt
    s_add_u32 m0, m0, 0x400
    s_nop 0
    global_load_lds_dwordx4 v143, s[32:33] nt
    s_add_u32 m0, m0, 0x400
    s_nop 0
    global_load_lds_dwordx4 v144, s[32:33] nt
    s_add_u32 m0, m0, 0x400
    s_nop 0
    global_load_lds_dwordx4 v145, s[32:33] nt
    s_add_u32 m0, m0, 0x400
    s_nop 0
    global_load_lds_dwordx4 v146, s[32:33] nt
    s_add_u32 m0, m0, 0x400
    s_nop 0
    s_add_u32 m0, s8, 0x6000
    s_nop 0
    global_load_lds_dwordx4 v212, s[28:29] nt
    s_add_u32 m0, m0, 0x400
    v_add_u32 v212, s45, v212
    global_load_lds_dwordx4 v212, s[28:29] nt
    s_add_u32 m0, m0, 0x400
    v_add_u32 v212, s45, v212
    global_load_lds_dwordx4 v212, s[28:29] nt
    s_add_u32 m0, m0, 0x400
    v_add_u32 v212, s45, v212
    global_load_lds_dwordx4 v212, s[28:29] nt
    s_add_u32 m0, m0, 0x400
    v_add_u32 v212, s45, v212
    global_load_lds_dwordx4 v212, s[28:29] nt
    s_add_u32 m0, m0, 0x400
    v_add_u32 v212, s45, v212
    global_load_lds_dwordx4 v212, s[28:29] nt
    s_add_u32 m0, m0, 0x400
    v_add_u32 v212, s45, v212
    global_load_lds_dwordx4 v212, s[28:29] nt
    global_load_dword v234, v215, s[30:31]
recurrent_scan__mha_block_cached__dense_activation_squared_relu__decode_kernel_stream0:
    global_load_dwordx4 v[80:83], v2, s[6:7] offset:0 nt
    global_load_dwordx4 v[84:87], v2, s[6:7] offset:1024 nt
    global_load_dwordx4 v[88:91], v2, s[6:7] offset:2048 nt
    global_load_dwordx4 v[92:95], v2, s[6:7] offset:3072 nt
    global_load_dwordx4 v[96:99], v3, s[6:7] offset:0 nt
    global_load_dwordx4 v[100:103], v3, s[6:7] offset:1024 nt
    global_load_dwordx4 v[104:107], v3, s[6:7] offset:2048 nt
    global_load_dwordx4 v[108:111], v3, s[6:7] offset:3072 nt
    s_add_u32 s6, s55, s48
    s_and_b32 s6, s6, 0x7f
    s_lshl_b32 s6, s6, 14
    s_add_u32 s4, s18, s6
    s_addc_u32 s5, s19, 0
    s_add_u32 s6, s4, 0x2000
    s_addc_u32 s7, s5, 0
    s_add_u32 s55, s55, 16
    s_lshl_b32 s46, s13, 12
    s_add_u32 s46, s46, 4096
    v_and_b32 v233, 31, v1
    v_lshlrev_b32 v233, 5, v233
    v_add_u32 v233, s46, v233
    s_lshl_b32 s46, s14, 10
    v_add_u32 v233, s46, v233
    s_lshl_b32 s45, s97, 8
    s_add_u32 s45, s45, 196608
    s_add_u32 s26, s40, s45
    s_addc_u32 s27, s41, 0
    v_mov_b32 v238, 1
    v_and_b32 v216, 1, v1
    v_mov_b32 v217, 0xffff
    v_lshlrev_b32 v216, 4, v216
    v_lshlrev_b32 v217, v216, v217
    v_lshrrev_b32 v219, 1, v1
    v_xor_b32 v219, v219, v1
    v_and_b32 v219, 8, v219
    v_bfe_u32 v218, v1, 1, 2
    v_or_b32 v218, v218, v219
    v_cmp_eq_u32 vcc, 0, v218
    s_nop 1
    v_cndmask_b32 v4, 0, v217, vcc
    v_cmp_eq_u32 vcc, 1, v218
    s_nop 1
    v_cndmask_b32 v5, 0, v217, vcc
    v_cmp_eq_u32 vcc, 2, v218
    s_nop 1
    v_cndmask_b32 v6, 0, v217, vcc
    v_cmp_eq_u32 vcc, 3, v218
    s_nop 1
    v_cndmask_b32 v7, 0, v217, vcc
    v_add_u32 v232, s8, v2
    v_mov_b32 v16, 0
    v_mov_b32 v17, 0xff7fffff
    s_mov_b32 s11, 0xff7fffff
    s_mov_b32 s44, 0x3db8aa3b
    v_mov_b32 v12, 0
    v_mov_b32 v13, 0
    v_mov_b32 v14, 0
    v_mov_b32 v15, 0
    s_mov_b32 s10, 0
    s_mov_b32 s42, 0x7fff
    s_mov_b32 s56, 0
    s_waitcnt lgkmcnt(0)
    s_lshr_b32 s49, s49, 8
    s_add_u32 s49, s49, 1
    s_or_b32 s49, s49, 0x80000000
    v_mov_b32 v235, s49
    s_and_b32 s96, s49, 0xfffff
    s_mov_b32 m0, s8
    s_nop 0
    global_load_lds_dwordx4 v2, s[4:5] offset:0 nt
    global_load_lds_dwordx4 v2, s[4:5] offset:1024 nt
    global_load_lds_dwordx4 v2, s[4:5] offset:2048 nt
    global_load_lds_dwordx4 v2, s[4:5] offset:3072 nt
    s_add_u32 m0, m0, 0x1000
    s_nop 0
    global_load_lds_dwordx4 v3, s[4:5] offset:0 nt
    global_load_lds_dwordx4 v3, s[4:5] offset:1024 nt
    global_load_lds_dwordx4 v3, s[4:5] offset:2048 nt
    global_load_lds_dwordx4 v3, s[4:5] offset:3072 nt
    v_add_u32 v200, 0, v1
    v_mul_u32_u24 v216, 4682, v200
    v_lshrrev_b32 v216, 16, v216
    v_mul_u32_u24 v217, 14, v216
    v_sub_u32 v200, v200, v217
    v_and_b32 v217, 3, v216
    v_lshrrev_b32 v216, 2, v216
    v_lshl_add_u32 v216, v217, 3, v216
    v_mul_u32_u24 v216, 896, v216
    v_lshl_add_u32 v200, v200, 4, v216
    v_add_u32 v201, 64, v1
    v_mul_u32_u24 v216, 4682, v201
    v_lshrrev_b32 v216, 16, v216
    v_mul_u32_u24 v217, 14, v216
    v_sub_u32 v201, v201, v217
    v_and_b32 v217, 3, v216
    v_lshrrev_b32 v216, 2, v216
    v_lshl_add_u32 v216, v217, 3, v216
    v_mul_u32_u24 v216, 896, v216
    v_lshl_add_u32 v201, v201, 4, v216
    v_add_u32 v202, 128, v1
    v_mul_u32_u24 v216, 4682, v202
    v_lshrrev_b32 v216, 16, v216
    v_mul_u32_u24 v217, 14, v216
    v_sub_u32 v202, v202, v217
    v_and_b32 v217, 3, v216
    v_lshrrev_b32 v216, 2, v216
    v_lshl_add_u32 v216, v217, 3, v216
    v_mul_u32_u24 v216, 896, v216
    v_lshl_add_u32 v202, v202, 4, v216
    v_add_u32 v203, 192, v1
    v_mul_u32_u24 v216, 4682, v203
    v_lshrrev_b32 v216, 16, v216
    v_mul_u32_u24 v217, 14, v216
    v_sub_u32 v203, v203, v217
    v_and_b32 v217, 3, v216
    v_lshrrev_b32 v216, 2, v216
    v_lshl_add_u32 v216, v217, 3, v216
    v_mul_u32_u24 v216, 896, v216
    v_lshl_add_u32 v203, v203, 4, v216
    v_add_u32 v204, 256, v1
    v_mul_u32_u24 v216, 4682, v204
    v_lshrrev_b32 v216, 16, v216
    v_mul_u32_u24 v217, 14, v216
    v_sub_u32 v204, v204, v217
    v_and_b32 v217, 3, v216
    v_lshrrev_b32 v216, 2, v216
    v_lshl_add_u32 v216, v217, 3, v216
    v_mul_u32_u24 v216, 896, v216
    v_lshl_add_u32 v204, v204, 4, v216
    v_add_u32 v205, 320, v1
    v_mul_u32_u24 v216, 4682, v205
    v_lshrrev_b32 v216, 16, v216
    v_mul_u32_u24 v217, 14, v216
    v_sub_u32 v205, v205, v217
    v_and_b32 v217, 3, v216
    v_lshrrev_b32 v216, 2, v216
    v_lshl_add_u32 v216, v217, 3, v216
    v_mul_u32_u24 v216, 896, v216
    v_lshl_add_u32 v205, v205, 4, v216
    v_add_u32 v206, 384, v1
    v_mul_u32_u24 v216, 4682, v206
    v_lshrrev_b32 v216, 16, v216
    v_mul_u32_u24 v217, 14, v216
    v_sub_u32 v206, v206, v217
    v_and_b32 v217, 3, v216
    v_lshrrev_b32 v216, 2, v216
    v_lshl_add_u32 v216, v217, 3, v216
    v_mul_u32_u24 v216, 896, v216
    v_lshl_add_u32 v206, v206, 4, v216
    s_mul_i32 s12, s13, 229376
    s_mul_i32 s46, s3, 224
    s_add_u32 s12, s12, s46
    s_add_u32 s52, s24, s12
    s_addc_u32 s53, s25, 0
    s_lshl_b32 s51, s13, 2
    s_add_u32 s51, s51, s47
    s_add_u32 m0, s8, 0x2000
    s_nop 0
    global_load_lds_dwordx4 v2, s[6:7] offset:0 nt
    global_load_lds_dwordx4 v2, s[6:7] offset:1024 nt
    global_load_lds_dwordx4 v2, s[6:7] offset:2048 nt
    global_load_lds_dwordx4 v2, s[6:7] offset:3072 nt
    s_add_u32 m0, m0, 0x1000
    s_nop 0
    global_load_lds_dwordx4 v3, s[6:7] offset:0 nt
    global_load_lds_dwordx4 v3, s[6:7] offset:1024 nt
    global_load_lds_dwordx4 v3, s[6:7] offset:2048 nt
    global_load_lds_dwordx4 v3, s[6:7] offset:3072 nt
    s_add_u32 s6, s55, s48
    s_and_b32 s6, s6, 0x7f
    s_lshl_b32 s6, s6, 14
    s_add_u32 s4, s18, s6
    s_addc_u32 s5, s19, 0
    s_add_u32 s6, s4, 0x2000
    s_addc_u32 s7, s5, 0
    s_add_u32 s55, s55, 16
    s_cmp_eq_u32 s54, 2
    s_cbranch_scc1 recurrent_scan__mha_block_cached__dense_activation_squared_relu__decode_kernel_ffn2
recurrent_scan__mha_block_cached__dense_activation_squared_relu__decode_kernel_ffn2x:
    s_add_u32 m0, s8, 0x4000
    s_nop 0
    global_load_lds_dwordx4 v2, s[4:5] offset:0 nt
    global_load_lds_dwordx4 v2, s[4:5] offset:1024 nt
    global_load_lds_dwordx4 v2, s[4:5] offset:2048 nt
    global_load_lds_dwordx4 v2, s[4:5] offset:3072 nt
    s_add_u32 m0, m0, 0x1000
    s_nop 0
    global_load_lds_dwordx4 v3, s[4:5] offset:0 nt
    global_load_lds_dwordx4 v3, s[4:5] offset:1024 nt
    global_load_lds_dwordx4 v3, s[4:5] offset:2048 nt
    global_load_lds_dwordx4 v3, s[4:5] offset:3072 nt
    v_bfe_u32 v207, v1, 2, 2
    v_lshl_add_u32 v207, v208, 3, v207
    v_mul_u32_u24 v207, 224, v207
    v_and_b32 v216, 3, v1
    v_lshl_add_u32 v207, v216, 3, v207
    v_add_u32 v207, s50, v207
    v_lshlrev_b32 v239, 3, v1
    v_add_u32 v239, s50, v239
    v_mul_u32_u24 v240, 7168, v216
    v_bfe_u32 v217, v1, 2, 2
    v_mul_u32_u24 v217, 0, v217
    v_add_u32 v240, v240, v217
    v_lshl_add_u32 v240, v208, 4, v240
    v_add_u32 v240, 131072, v240
    s_mul_i32 s12, s3, 28672
    s_lshl_b32 s46, s51, 6
    s_add_u32 s12, s12, s46
    s_mul_i32 s46, s14, 114688
    s_add_u32 s12, s12, s46
    s_add_u32 s12, s12, 2097152
    v_lshlrev_b32 v241, 12, v208
    v_and_b32 v216, 12, v1
    v_lshl_add_u32 v241, v216, 2, v241
    v_add_u32 v241, s12, v241
    s_add_u32 m0, s8, 0x6000
    s_nop 0
    global_load_lds_dwordx4 v2, s[6:7] offset:0 nt
    global_load_lds_dwordx4 v2, s[6:7] offset:1024 nt
    global_load_lds_dwordx4 v2, s[6:7] offset:2048 nt
    global_load_lds_dwordx4 v2, s[6:7] offset:3072 nt
    s_add_u32 m0, m0, 0x1000
    s_nop 0
    global_load_lds_dwordx4 v3, s[6:7] offset:0 nt
    global_load_lds_dwordx4 v3, s[6:7] offset:1024 nt
    global_load_lds_dwordx4 v3, s[6:7] offset:2048 nt
    global_load_lds_dwordx4 v3, s[6:7] offset:3072 nt
    s_add_u32 s6, s55, s48
    s_and_b32 s6, s6, 0x7f
    s_lshl_b32 s6, s6, 14
    s_add_u32 s4, s18, s6
    s_addc_u32 s5, s19, 0
    s_add_u32 s6, s4, 0x2000
    s_addc_u32 s7, s5, 0
    s_add_u32 s55, s55, 16
    s_mul_i32 s58, s2, 37
    s_lshr_b32 s58, s58, 8
    s_lshl_b32 s59, s2, 2
    s_add_u32 s59, s59, s3
    s_lshl_b32 s12, s59, 12
    s_add_u32 s46, s12, 2097152
    s_add_u32 s60, s40, s46
    s_addc_u32 s61, s41, 0
    s_lshl_b32 s12, s59, 12
    s_add_u32 s46, s12, 1048576
    s_add_u32 s62, s40, s46
    s_addc_u32 s63, s41, 0
    s_lshl_b32 s12, s2, 10
    s_add_u32 s12, s12, 131072
    v_add_u32 v242, s12, v2
    v_and_b32 v245, 3, v1
    v_lshlrev_b32 v245, 3, v245
    v_lshrrev_b32 v244, 5, v1
    v_lshl_add_u32 v245, v244, 1, v245
    v_bfe_u32 v244, v1, 4, 1
    v_lshl_add_u32 v245, v244, 2, v245
    s_lshl_b32 s12, s59, 5
    v_add_u32 v245, s12, v245
    s_mul_i32 s12, s58, 896
    v_subrev_u32 v244, s12, v245
    v_and_b32 v243, 0xfc, v1
    s_mov_b32 s98, 0
    s_mov_b32 s22, 4
    global_load_dwordx4 v[112:115], v2, s[4:5] offset:0 nt
    global_load_dwordx4 v[116:119], v2, s[4:5] offset:1024 nt
    global_load_dwordx4 v[120:123], v2, s[4:5] offset:2048 nt
    global_load_dwordx4 v[124:127], v2, s[4:5] offset:3072 nt
    global_load_dwordx4 v[128:131], v3, s[4:5] offset:0 nt
    global_load_dwordx4 v[132:135], v3, s[4:5] offset:1024 nt
    global_load_dwordx4 v[136:139], v3, s[4:5] offset:2048 nt
    global_load_dwordx4 v[140:143], v3, s[4:5] offset:3072 nt
    global_load_dwordx4 v[20:23], v233, s[40:41] offset:0 sc1
    global_load_dwordx4 v[24:27], v233, s[40:41] offset:16 sc1
    global_load_dwordx4 v[144:147], v2, s[6:7] offset:0 nt
    global_load_dwordx4 v[148:151], v2, s[6:7] offset:1024 nt
    global_load_dwordx4 v[152:155], v2, s[6:7] offset:2048 nt
    global_load_dwordx4 v[156:159], v2, s[6:7] offset:3072 nt
    global_load_dwordx4 v[160:163], v3, s[6:7] offset:0 nt
    global_load_dwordx4 v[164:167], v3, s[6:7] offset:1024 nt
    global_load_dwordx4 v[168:171], v3, s[6:7] offset:2048 nt
    global_load_dwordx4 v[172:175], v3, s[6:7] offset:3072 nt
    s_waitcnt vmcnt(8)
recurrent_scan__mha_block_cached__dense_activation_squared_relu__decode_kernel_qchk:
    v_mov_b32 v32, 0
    v_bitop3_b32 v32, v32, v21, v235 bitop3:0xf6
    v_bitop3_b32 v32, v32, v23, v235 bitop3:0xf6
    v_bitop3_b32 v32, v32, v25, v235 bitop3:0xf6
    v_bitop3_b32 v32, v32, v27, v235 bitop3:0xf6
    v_cmp_ne_u32 vcc, 0, v32
    s_add_u32 s56, s56, 1
    s_cmp_gt_u32 s56, 262144
    s_cbranch_vccz recurrent_scan__mha_block_cached__dense_activation_squared_relu__decode_kernel_qok
    s_cbranch_scc1 recurrent_scan__mha_block_cached__dense_activation_squared_relu__decode_kernel_qok
    global_load_dwordx4 v[20:23], v233, s[40:41] offset:0 sc1
    global_load_dwordx4 v[24:27], v233, s[40:41] offset:16 sc1
    s_waitcnt vmcnt(0)
    s_branch recurrent_scan__mha_block_cached__dense_activation_squared_relu__decode_kernel_qchk
recurrent_scan__mha_block_cached__dense_activation_squared_relu__decode_kernel_qok:
    v_mov_b32 v8, v20
    v_mov_b32 v9, v22
    v_mov_b32 v10, v24
    v_mov_b32 v11, v26
    s_lshl_b32 s12, s3, 9
    s_add_u32 s12, s12, 160000
    v_and_b32 v30, 0xfc, v1
    v_add_u32 v30, s12, v30
    s_branch recurrent_scan__mha_block_cached__dense_activation_squared_relu__decode_kernel_k1
recurrent_scan__mha_block_cached__dense_activation_squared_relu__decode_kernel_ffn2:
    s_waitcnt vmcnt(46)
    v_lshlrev_b32 v168, 16, v126
    v_and_b32 v169, 0xffff0000, v126
    v_lshlrev_b32 v170, 16, v127
    v_and_b32 v171, 0xffff0000, v127
    v_lshlrev_b32 v172, 16, v128
    v_and_b32 v173, 0xffff0000, v128
    v_lshlrev_b32 v174, 16, v129
    v_and_b32 v175, 0xffff0000, v129
    v_lshlrev_b32 v176, 16, v130
    v_and_b32 v177, 0xffff0000, v130
    v_lshlrev_b32 v178, 16, v131
    v_and_b32 v179, 0xffff0000, v131
    v_lshlrev_b32 v180, 16, v132
    v_and_b32 v181, 0xffff0000, v132
    v_lshlrev_b32 v182, 16, v133
    v_and_b32 v183, 0xffff0000, v133
    v_lshlrev_b32 v184, 16, v134
    v_and_b32 v185, 0xffff0000, v134
    v_lshlrev_b32 v186, 16, v135
    v_and_b32 v187, 0xffff0000, v135
    v_lshlrev_b32 v188, 16, v136
    v_and_b32 v189, 0xffff0000, v136
    v_lshlrev_b32 v190, 16, v137
    v_and_b32 v191, 0xffff0000, v137
    v_lshlrev_b32 v192, 16, v138
    v_and_b32 v193, 0xffff0000, v138
    v_lshlrev_b32 v194, 16, v139
    v_and_b32 v195, 0xffff0000, v139
    v_add_f32 v220, v168, v169
    v_add_f32 v221, v170, v171
    v_add_f32 v220, v220, v172
    v_add_f32 v221, v221, v173
    v_add_f32 v220, v220, v174
    v_add_f32 v221, v221, v175
    v_add_f32 v220, v220, v176
    v_add_f32 v221, v221, v177
    v_add_f32 v220, v220, v178
    v_add_f32 v221, v221, v179
    v_add_f32 v220, v220, v180
    v_add_f32 v221, v221, v181
    v_add_f32 v220, v220, v182
    v_add_f32 v221, v221, v183
    v_add_f32 v220, v220, v184
    v_add_f32 v221, v221, v185
    v_add_f32 v220, v220, v186
    v_add_f32 v221, v221, v187
    v_add_f32 v220, v220, v188
    v_add_f32 v221, v221, v189
    v_add_f32 v220, v220, v190
    v_add_f32 v221, v221, v191
    v_add_f32 v220, v220, v192
    v_add_f32 v221, v221, v193
    v_add_f32 v220, v220, v194
    v_add_f32 v221, v221, v195
    v_add_f32 v220, v220, v221
    s_nop 1
    v_add_f32_dpp v220, v220, v220 row_ror:8 row_mask:0xf bank_mask:0xf
    s_nop 1
    v_add_f32_dpp v220, v220, v220 row_ror:4 row_mask:0xf bank_mask:0xf
    s_nop 1
    v_add_f32_dpp v220, v220, v220 row_ror:2 row_mask:0xf bank_mask:0xf
    s_nop 1
    v_add_f32_dpp v220, v220, v220 row_ror:1 row_mask:0xf bank_mask:0xf
    v_mul_f32 v220, 0x3b124925, v220
    v_sub_f32 v168, v168, v220
    v_sub_f32 v169, v169, v220
    v_sub_f32 v170, v170, v220
    v_sub_f32 v171, v171, v220
    v_sub_f32 v172, v172, v220
    v_sub_f32 v173, v173, v220
    v_sub_f32 v174, v174, v220
    v_sub_f32 v175, v175, v220
    v_sub_f32 v176, v176, v220
    v_sub_f32 v177, v177, v220
    v_sub_f32 v178, v178, v220
    v_sub_f32 v179, v179, v220
    v_sub_f32 v180, v180, v220
    v_sub_f32 v181, v181, v220
    v_sub_f32 v182, v182, v220
    v_sub_f32 v183, v183, v220
    v_sub_f32 v184, v184, v220
    v_sub_f32 v185, v185, v220
    v_sub_f32 v186, v186, v220
    v_sub_f32 v187, v187, v220
    v_sub_f32 v188, v188, v220
    v_sub_f32 v189, v189, v220
    v_sub_f32 v190, v190, v220
    v_sub_f32 v191, v191, v220
    v_sub_f32 v192, v192, v220
    v_sub_f32 v193, v193, v220
    v_sub_f32 v194, v194, v220
    v_sub_f32 v195, v195, v220
    v_mul_f32 v221, v168, v168
    v_mul_f32 v222, v169, v169
    v_fmac_f32 v221, v170, v170
    v_fmac_f32 v222, v171, v171
    v_fmac_f32 v221, v172, v172
    v_fmac_f32 v222, v173, v173
    v_fmac_f32 v221, v174, v174
    v_fmac_f32 v222, v175, v175
    v_fmac_f32 v221, v176, v176
    v_fmac_f32 v222, v177, v177
    v_fmac_f32 v221, v178, v178
    v_fmac_f32 v222, v179, v179
    v_fmac_f32 v221, v180, v180
    v_fmac_f32 v222, v181, v181
    v_fmac_f32 v221, v182, v182
    v_fmac_f32 v222, v183, v183
    v_fmac_f32 v221, v184, v184
    v_fmac_f32 v222, v185, v185
    v_fmac_f32 v221, v186, v186
    v_fmac_f32 v222, v187, v187
    v_fmac_f32 v221, v188, v188
    v_fmac_f32 v222, v189, v189
    v_fmac_f32 v221, v190, v190
    v_fmac_f32 v222, v191, v191
    v_fmac_f32 v221, v192, v192
    v_fmac_f32 v222, v193, v193
    v_fmac_f32 v221, v194, v194
    v_fmac_f32 v222, v195, v195
    v_add_f32 v221, v221, v222
    s_nop 1
    v_add_f32_dpp v221, v221, v221 row_ror:8 row_mask:0xf bank_mask:0xf
    s_nop 1
    v_add_f32_dpp v221, v221, v221 row_ror:4 row_mask:0xf bank_mask:0xf
    s_nop 1
    v_add_f32_dpp v221, v221, v221 row_ror:2 row_mask:0xf bank_mask:0xf
    s_nop 1
    v_add_f32_dpp v221, v221, v221 row_ror:1 row_mask:0xf bank_mask:0xf
    v_mul_f32 v221, 0x3b124925, v221
    v_cvt_pk_bf16_f32 v221, v221, v220
    v_and_b32 v224, 0xffff0000, v221
    v_lshlrev_b32 v221, 16, v221
    v_add_f32 v221, 0x3727c5ac, v221
    v_cvt_pk_bf16_f32 v221, v221, v221
    v_lshlrev_b32 v221, 16, v221
    v_sqrt_f32 v221, v221
    s_nop 0
    v_cvt_pk_bf16_f32 v221, v221, v221
    v_lshlrev_b32 v221, 16, v221
    v_rcp_f32 v225, v221
    ds_bpermute_b32 v224, v214, v224
    ds_bpermute_b32 v225, v214, v225
    s_waitcnt vmcnt(39)
    v_lshlrev_b32 v168, 16, v112
    v_and_b32 v169, 0xffff0000, v112
    v_lshlrev_b32 v170, 16, v113
    v_and_b32 v171, 0xffff0000, v113
    v_lshlrev_b32 v172, 16, v114
    v_and_b32 v173, 0xffff0000, v114
    v_lshlrev_b32 v174, 16, v115
    v_and_b32 v175, 0xffff0000, v115
    v_lshlrev_b32 v176, 16, v116
    v_and_b32 v177, 0xffff0000, v116
    v_lshlrev_b32 v178, 16, v117
    v_and_b32 v179, 0xffff0000, v117
    v_lshlrev_b32 v180, 16, v118
    v_and_b32 v181, 0xffff0000, v118
    v_lshlrev_b32 v182, 16, v119
    v_and_b32 v183, 0xffff0000, v119
    v_lshlrev_b32 v184, 16, v120
    v_and_b32 v185, 0xffff0000, v120
    v_lshlrev_b32 v186, 16, v121
    v_and_b32 v187, 0xffff0000, v121
    v_lshlrev_b32 v188, 16, v122
    v_and_b32 v189, 0xffff0000, v122
    v_lshlrev_b32 v190, 16, v123
    v_and_b32 v191, 0xffff0000, v123
    v_lshlrev_b32 v192, 16, v124
    v_and_b32 v193, 0xffff0000, v124
    v_lshlrev_b32 v194, 16, v125
    v_and_b32 v195, 0xffff0000, v125
    s_waitcnt lgkmcnt(0)
    v_sub_f32 v168, v168, v224
    v_sub_f32 v169, v169, v224
    v_sub_f32 v170, v170, v224
    v_sub_f32 v171, v171, v224
    v_sub_f32 v172, v172, v224
    v_sub_f32 v173, v173, v224
    v_sub_f32 v174, v174, v224
    v_sub_f32 v175, v175, v224
    v_sub_f32 v176, v176, v224
    v_sub_f32 v177, v177, v224
    v_sub_f32 v178, v178, v224
    v_sub_f32 v179, v179, v224
    v_sub_f32 v180, v180, v224
    v_sub_f32 v181, v181, v224
    v_sub_f32 v182, v182, v224
    v_sub_f32 v183, v183, v224
    v_sub_f32 v184, v184, v224
    v_sub_f32 v185, v185, v224
    v_sub_f32 v186, v186, v224
    v_sub_f32 v187, v187, v224
    v_sub_f32 v188, v188, v224
    v_sub_f32 v189, v189, v224
    v_sub_f32 v190, v190, v224
    v_sub_f32 v191, v191, v224
    v_sub_f32 v192, v192, v224
    v_sub_f32 v193, v193, v224
    v_sub_f32 v194, v194, v224
    v_sub_f32 v195, v195, v224
    v_cvt_pk_bf16_f32 v112, v168, v169
    v_cvt_pk_bf16_f32 v113, v170, v171
    v_cvt_pk_bf16_f32 v114, v172, v173
    v_cvt_pk_bf16_f32 v115, v174, v175
    v_cvt_pk_bf16_f32 v116, v176, v177
    v_cvt_pk_bf16_f32 v117, v178, v179
    v_cvt_pk_bf16_f32 v118, v180, v181
    v_cvt_pk_bf16_f32 v119, v182, v183
    v_cvt_pk_bf16_f32 v120, v184, v185
    v_cvt_pk_bf16_f32 v121, v186, v187
    v_cvt_pk_bf16_f32 v122, v188, v189
    v_cvt_pk_bf16_f32 v123, v190, v191
    v_cvt_pk_bf16_f32 v124, v192, v193
    v_cvt_pk_bf16_f32 v125, v194, v195
    v_lshlrev_b32 v168, 16, v112
    v_and_b32 v169, 0xffff0000, v112
    v_lshlrev_b32 v170, 16, v113
    v_and_b32 v171, 0xffff0000, v113
    v_lshlrev_b32 v172, 16, v114
    v_and_b32 v173, 0xffff0000, v114
    v_lshlrev_b32 v174, 16, v115
    v_and_b32 v175, 0xffff0000, v115
    v_lshlrev_b32 v176, 16, v116
    v_and_b32 v177, 0xffff0000, v116
    v_lshlrev_b32 v178, 16, v117
    v_and_b32 v179, 0xffff0000, v117
    v_lshlrev_b32 v180, 16, v118
    v_and_b32 v181, 0xffff0000, v118
    v_lshlrev_b32 v182, 16, v119
    v_and_b32 v183, 0xffff0000, v119
    v_lshlrev_b32 v184, 16, v120
    v_and_b32 v185, 0xffff0000, v120
    v_lshlrev_b32 v186, 16, v121
    v_and_b32 v187, 0xffff0000, v121
    v_lshlrev_b32 v188, 16, v122
    v_and_b32 v189, 0xffff0000, v122
    v_lshlrev_b32 v190, 16, v123
    v_and_b32 v191, 0xffff0000, v123
    v_lshlrev_b32 v192, 16, v124
    v_and_b32 v193, 0xffff0000, v124
    v_lshlrev_b32 v194, 16, v125
    v_and_b32 v195, 0xffff0000, v125
    v_mul_f32 v168, v168, v225
    v_mul_f32 v169, v169, v225
    v_mul_f32 v170, v170, v225
    v_mul_f32 v171, v171, v225
    v_mul_f32 v172, v172, v225
    v_mul_f32 v173, v173, v225
    v_mul_f32 v174, v174, v225
    v_mul_f32 v175, v175, v225
    v_mul_f32 v176, v176, v225
    v_mul_f32 v177, v177, v225
    v_mul_f32 v178, v178, v225
    v_mul_f32 v179, v179, v225
    v_mul_f32 v180, v180, v225
    v_mul_f32 v181, v181, v225
    v_mul_f32 v182, v182, v225
    v_mul_f32 v183, v183, v225
    v_mul_f32 v184, v184, v225
    v_mul_f32 v185, v185, v225
    v_mul_f32 v186, v186, v225
    v_mul_f32 v187, v187, v225
    v_mul_f32 v188, v188, v225
    v_mul_f32 v189, v189, v225
    v_mul_f32 v190, v190, v225
    v_mul_f32 v191, v191, v225
    v_mul_f32 v192, v192, v225
    v_mul_f32 v193, v193, v225
    v_mul_f32 v194, v194, v225
    v_mul_f32 v195, v195, v225
    v_cvt_pk_bf16_f32 v112, v168, v169
    v_cvt_pk_bf16_f32 v113, v170, v171
    v_cvt_pk_bf16_f32 v114, v172, v173
    v_cvt_pk_bf16_f32 v115, v174, v175
    v_cvt_pk_bf16_f32 v116, v176, v177
    v_cvt_pk_bf16_f32 v117, v178, v179
    v_cvt_pk_bf16_f32 v118, v180, v181
    v_cvt_pk_bf16_f32 v119, v182, v183
    v_cvt_pk_bf16_f32 v120, v184, v185
    v_cvt_pk_bf16_f32 v121, v186, v187
    v_cvt_pk_bf16_f32 v122, v188, v189
    v_cvt_pk_bf16_f32 v123, v190, v191
    v_cvt_pk_bf16_f32 v124, v192, v193
    v_cvt_pk_bf16_f32 v125, v194, v195
    v_lshrrev_b32 v216, 2, v1
    v_lshlrev_b32 v216, 6, v216
    v_and_b32 v217, 3, v1
    v_lshl_add_u32 v216, v217, 3, v216
    s_add_u32 s45, s8, 0x6000
    v_add_u32 v216, s45, v216
    s_waitcnt vmcnt(24)
    ds_read_b64_tr_b16 v[140:141], v216 offset:0
    ds_read_b64_tr_b16 v[142:143], v216 offset:32
    ds_read_b64_tr_b16 v[144:145], v216 offset:1024
    ds_read_b64_tr_b16 v[146:147], v216 offset:1056
    ds_read_b64_tr_b16 v[148:149], v216 offset:2048
    ds_read_b64_tr_b16 v[150:151], v216 offset:2080
    ds_read_b64_tr_b16 v[152:153], v216 offset:3072
    ds_read_b64_tr_b16 v[154:155], v216 offset:3104
    ds_read_b64_tr_b16 v[156:157], v216 offset:4096
    ds_read_b64_tr_b16 v[158:159], v216 offset:4128
    ds_read_b64_tr_b16 v[160:161], v216 offset:5120
    ds_read_b64_tr_b16 v[162:163], v216 offset:5152
    ds_read_b64_tr_b16 v[164:165], v216 offset:6144
    ds_read_b64_tr_b16 v[166:167], v216 offset:6176
    v_lshlrev_b32 v217, 9, v208
    v_lshl_add_u32 v217, v209, 2, v217
    v_add_u32 v217, s50, v217
    v_lshlrev_b32 v219, 3, v209
    v_add_u32 v219, 131072, v219
    v_lshl_add_u32 v218, v208, 7, v219
    s_waitcnt lgkmcnt(0)
    v_mfma_f32_16x16x16_bf16 v[40:43], v[112:113], v[140:141], 0
    v_mfma_f32_16x16x16_bf16 v[44:47], v[112:113], v[142:143], 0
    v_mfma_f32_16x16x16_bf16 v[40:43], v[114:115], v[144:145], v[40:43]
    v_mfma_f32_16x16x16_bf16 v[44:47], v[114:115], v[146:147], v[44:47]
    v_mfma_f32_16x16x16_bf16 v[40:43], v[116:117], v[148:149], v[40:43]
    v_mfma_f32_16x16x16_bf16 v[44:47], v[116:117], v[150:151], v[44:47]
    v_mfma_f32_16x16x16_bf16 v[40:43], v[118:119], v[152:153], v[40:43]
    v_mfma_f32_16x16x16_bf16 v[44:47], v[118:119], v[154:155], v[44:47]
    v_mfma_f32_16x16x16_bf16 v[40:43], v[120:121], v[156:157], v[40:43]
    v_mfma_f32_16x16x16_bf16 v[44:47], v[120:121], v[158:159], v[44:47]
    v_mfma_f32_16x16x16_bf16 v[40:43], v[122:123], v[160:161], v[40:43]
    v_mfma_f32_16x16x16_bf16 v[44:47], v[122:123], v[162:163], v[44:47]
    v_mfma_f32_16x16x16_bf16 v[40:43], v[124:125], v[164:165], v[40:43]
    v_mfma_f32_16x16x16_bf16 v[44:47], v[124:125], v[166:167], v[44:47]
    v_bfe_u32 v212, v1, 2, 2
    v_lshl_add_u32 v212, v208, 3, v212
    v_mul_u32_u24 v212, 224, v212
    v_and_b32 v213, 3, v1
    v_lshl_add_u32 v212, v213, 3, v212
    s_add_u32 s45, s8, 0x4000
    v_add_u32 v212, s45, v212
    s_mov_b64 exec, 0xffff
    ds_write_b32 v217, v40 offset:0
    ds_write_b32 v217, v41 offset:128
    ds_write_b32 v217, v42 offset:256
    ds_write_b32 v217, v43 offset:384
    ds_write_b32 v217, v44 offset:64
    ds_write_b32 v217, v45 offset:192
    ds_write_b32 v217, v46 offset:320
    ds_write_b32 v217, v47 offset:448
    s_mov_b64 exec, -1
    ds_read_b64_tr_b16 v[140:141], v212 offset:0
    ds_read_b64_tr_b16 v[142:143], v212 offset:896
    ds_read_b64_tr_b16 v[144:145], v212 offset:32
    ds_read_b64_tr_b16 v[146:147], v212 offset:928
    ds_read_b64_tr_b16 v[148:149], v212 offset:64
    ds_read_b64_tr_b16 v[150:151], v212 offset:960
    ds_read_b64_tr_b16 v[152:153], v212 offset:96
    ds_read_b64_tr_b16 v[154:155], v212 offset:992
    ds_read_b64_tr_b16 v[156:157], v212 offset:128
    ds_read_b64_tr_b16 v[158:159], v212 offset:1024
    ds_read_b64_tr_b16 v[160:161], v212 offset:160
    ds_read_b64_tr_b16 v[162:163], v212 offset:1056
    ds_read_b64_tr_b16 v[164:165], v212 offset:192
    ds_read_b64_tr_b16 v[166:167], v212 offset:1088
    s_waitcnt lgkmcnt(0)
    s_barrier
    ds_read_b64 v[168:169], v218 offset:0
    ds_read_b64 v[170:171], v218 offset:7168
    ds_read_b64 v[172:173], v218 offset:14336
    ds_read_b64 v[174:175], v218 offset:21504
    s_lshl_b32 s45, s3, 9
    s_add_u32 s45, s45, 160000
    v_lshlrev_b32 v216, 2, v1
    v_add_u32 v216, s45, v216
    v_and_b32 v217, 3, v1
    v_lshlrev_b32 v217, 6, v217
    v_lshl_add_u32 v217, v208, 4, v217
    v_add_u32 v217, s45, v217
    v_lshlrev_b32 v36, 16, v234
    v_and_b32 v37, 0xffff0000, v234
    s_waitcnt lgkmcnt(0)
    s_barrier
    v_add_f32 v168, v168, v170
    v_add_f32 v172, v172, v174
    v_add_f32 v168, v168, v172
    v_add_f32 v169, v169, v171
    v_add_f32 v173, v173, v175
    v_add_f32 v169, v169, v173
    v_cvt_pk_bf16_f32 v168, v168, v169
    v_and_b32 v169, 0xffff0000, v168
    v_lshlrev_b32 v168, 16, v168
    v_add_f32 v168, v168, v36
    v_add_f32 v169, v169, v37
    v_cvt_pk_bf16_f32 v168, v168, v169
    v_and_b32 v169, 0xffff0000, v168
    v_lshlrev_b32 v168, 16, v168
    v_max_f32 v168, 0, v168
    v_max_f32 v169, 0, v169
    v_mul_f32 v168, v168, v168
    v_mul_f32 v169, v169, v169
    v_cvt_pk_bf16_f32 v168, v168, v169
    ds_write_b32 v216, v168
    ds_read_b128 v[40:43], v217
    s_lshl_b32 s45, s43, 6
    s_mul_i32 s46, s3, 28672
    s_add_u32 s45, s45, s46
    s_add_u32 s45, s45, 1048576
    v_mul_u32_u24 v218, 114688, v208
    v_and_b32 v219, 12, v1
    v_lshl_add_u32 v218, v219, 2, v218
    v_add_u32 v218, s45, v218
    s_mov_b32 s45, 0x1000
    s_waitcnt lgkmcnt(0)
    v_mfma_f32_16x16x32_bf16 v[168:171], v[40:43], v[140:143], 0
    v_mfma_f32_16x16x32_bf16 v[172:175], v[40:43], v[144:147], 0
    v_mfma_f32_16x16x32_bf16 v[176:179], v[40:43], v[148:151], 0
    v_mfma_f32_16x16x32_bf16 v[180:183], v[40:43], v[152:155], 0
    v_mfma_f32_16x16x32_bf16 v[184:187], v[40:43], v[156:159], 0
    v_mfma_f32_16x16x32_bf16 v[188:191], v[40:43], v[160:163], 0
    v_mfma_f32_16x16x32_bf16 v[192:195], v[40:43], v[164:167], 0
    s_nop 2
    v_permlane16_swap_b32 v168, v169
    v_permlane16_swap_b32 v170, v171
    v_permlane16_swap_b32 v172, v173
    v_permlane16_swap_b32 v174, v175
    v_permlane16_swap_b32 v176, v177
    v_permlane16_swap_b32 v178, v179
    v_permlane16_swap_b32 v180, v181
    v_permlane16_swap_b32 v182, v183
    v_permlane16_swap_b32 v184, v185
    v_permlane16_swap_b32 v186, v187
    v_permlane16_swap_b32 v188, v189
    v_permlane16_swap_b32 v190, v191
    v_permlane16_swap_b32 v192, v193
    v_permlane16_swap_b32 v194, v195
    v_permlane32_swap_b32 v168, v170
    v_permlane32_swap_b32 v172, v174
    v_permlane32_swap_b32 v176, v178
    v_permlane32_swap_b32 v180, v182
    v_permlane32_swap_b32 v184, v186
    v_permlane32_swap_b32 v188, v190
    v_permlane32_swap_b32 v192, v194
    v_mov_b32_dpp v170, v168 quad_perm:[1,0,3,2] row_mask:0xf bank_mask:0xf
    v_mov_b32 v169, v235
    v_mov_b32 v171, v235
    v_mov_b32_dpp v174, v172 quad_perm:[1,0,3,2] row_mask:0xf bank_mask:0xf
    v_mov_b32 v173, v235
    v_mov_b32 v175, v235
    v_mov_b32_dpp v178, v176 quad_perm:[1,0,3,2] row_mask:0xf bank_mask:0xf
    v_mov_b32 v177, v235
    v_mov_b32 v179, v235
    v_mov_b32_dpp v182, v180 quad_perm:[1,0,3,2] row_mask:0xf bank_mask:0xf
    v_mov_b32 v181, v235
    v_mov_b32 v183, v235
    v_mov_b32_dpp v186, v184 quad_perm:[1,0,3,2] row_mask:0xf bank_mask:0xf
    v_mov_b32 v185, v235
    v_mov_b32 v187, v235
    v_mov_b32_dpp v190, v188 quad_perm:[1,0,3,2] row_mask:0xf bank_mask:0xf
    v_mov_b32 v189, v235
    v_mov_b32 v191, v235
    v_mov_b32_dpp v194, v192 quad_perm:[1,0,3,2] row_mask:0xf bank_mask:0xf
    v_mov_b32 v193, v235
    v_mov_b32 v195, v235
    v_cvt_pk_bf16_f32 v168, v168, v170
    v_cvt_pk_bf16_f32 v172, v172, v174
    v_cvt_pk_bf16_f32 v176, v176, v178
    v_cvt_pk_bf16_f32 v180, v180, v182
    v_cvt_pk_bf16_f32 v184, v184, v186
    v_cvt_pk_bf16_f32 v188, v188, v190
    v_cvt_pk_bf16_f32 v192, v192, v194
    v_mov_b32_dpp v170, v168 quad_perm:[2,2,2,2] row_mask:0xf bank_mask:0xf
    v_mov_b32_dpp v174, v172 quad_perm:[2,2,2,2] row_mask:0xf bank_mask:0xf
    v_mov_b32_dpp v178, v176 quad_perm:[2,2,2,2] row_mask:0xf bank_mask:0xf
    v_mov_b32_dpp v182, v180 quad_perm:[2,2,2,2] row_mask:0xf bank_mask:0xf
    v_mov_b32_dpp v186, v184 quad_perm:[2,2,2,2] row_mask:0xf bank_mask:0xf
    v_mov_b32_dpp v190, v188 quad_perm:[2,2,2,2] row_mask:0xf bank_mask:0xf
    v_mov_b32_dpp v194, v192 quad_perm:[2,2,2,2] row_mask:0xf bank_mask:0xf
    s_mov_b32 exec_lo, 0x11111111
    s_mov_b32 exec_hi, 0x11111111
    global_store_dwordx4 v218, v[168:171], s[40:41] sc1
    v_add_u32 v218, s45, v218
    global_store_dwordx4 v218, v[172:175], s[40:41] sc1
    v_add_u32 v218, s45, v218
    global_store_dwordx4 v218, v[176:179], s[40:41] sc1
    v_add_u32 v218, s45, v218
    global_store_dwordx4 v218, v[180:183], s[40:41] sc1
    v_add_u32 v218, s45, v218
    global_store_dwordx4 v218, v[184:187], s[40:41] sc1
    v_add_u32 v218, s45, v218
    global_store_dwordx4 v218, v[188:191], s[40:41] sc1
    v_add_u32 v218, s45, v218
    global_store_dwordx4 v218, v[192:195], s[40:41] sc1
    s_mov_b64 exec, -1
    s_branch recurrent_scan__mha_block_cached__dense_activation_squared_relu__decode_kernel_ffn2x
recurrent_scan__mha_block_cached__dense_activation_squared_relu__decode_kernel_loop:
    s_sub_u32 s57, s42, s10
    s_cmp_eq_u32 s10, 3
    s_cbranch_scc1 recurrent_scan__mha_block_cached__dense_activation_squared_relu__decode_kernel_xk
    s_cmp_ge_u32 s57, 2
    s_cbranch_scc1 recurrent_scan__mha_block_cached__dense_activation_squared_relu__decode_kernel_wk24
    s_waitcnt vmcnt(8)
recurrent_scan__mha_block_cached__dense_activation_squared_relu__decode_kernel_wk24:
    s_waitcnt vmcnt(24)
    s_sub_u32 s12, s10, 7
    s_min_u32 s45, s12, 7
    s_and_b32 s98, s10, 1
    s_cmp_lt_u32 s10, 14
    s_cselect_b32 s98, 1, s98
    s_cmp_lt_u32 s10, 7
    s_cselect_b32 s98, 0, s98
    s_lshl_b32 s45, s45, 6
    v_add_u32 v209, s45, v30
    v_add_u32 v208, s9, v232
    ds_read_b32 v20, v209
    ds_read_b128 v[48:51], v208 offset:0
    ds_read_b128 v[52:55], v208 offset:1024
    ds_read_b128 v[56:59], v208 offset:2048
    ds_read_b128 v[60:63], v208 offset:3072
    ds_read_b128 v[64:67], v208 offset:4096
    ds_read_b128 v[68:71], v208 offset:5120
    ds_read_b128 v[72:75], v208 offset:6144
    ds_read_b128 v[76:79], v208 offset:7168
    s_cmp_lg_u32 s98, 0
    s_cbranch_scc1 recurrent_scan__mha_block_cached__dense_activation_squared_relu__decode_kernel_v1
    s_waitcnt lgkmcnt(0)
recurrent_scan__mha_block_cached__dense_activation_squared_relu__decode_kernel_k1:
    v_dot2_f32_bf16 v32, v48, v8, 0
    v_dot2_f32_bf16 v33, v52, v8, 0
    v_dot2_f32_bf16 v34, v56, v8, 0
    v_dot2_f32_bf16 v35, v60, v8, 0
    v_dot2_f32_bf16 v36, v64, v8, 0
    v_dot2_f32_bf16 v37, v68, v8, 0
    v_dot2_f32_bf16 v38, v72, v8, 0
    v_dot2_f32_bf16 v39, v76, v8, 0
    v_dot2c_f32_bf16 v32, v49, v9
    v_dot2c_f32_bf16 v33, v53, v9
    v_dot2c_f32_bf16 v34, v57, v9
    v_dot2c_f32_bf16 v35, v61, v9
    v_dot2c_f32_bf16 v36, v65, v9
    v_dot2c_f32_bf16 v37, v69, v9
    v_dot2c_f32_bf16 v38, v73, v9
    v_dot2c_f32_bf16 v39, v77, v9
    v_dot2c_f32_bf16 v32, v50, v10
    v_dot2c_f32_bf16 v33, v54, v10
    v_dot2c_f32_bf16 v34, v58, v10
    v_dot2c_f32_bf16 v35, v62, v10
    v_dot2c_f32_bf16 v36, v66, v10
    v_dot2c_f32_bf16 v37, v70, v10
    v_dot2c_f32_bf16 v38, v74, v10
    v_dot2c_f32_bf16 v39, v78, v10
    v_dot2c_f32_bf16 v32, v51, v11
    v_dot2c_f32_bf16 v33, v55, v11
    v_dot2c_f32_bf16 v34, v59, v11
    v_dot2c_f32_bf16 v35, v63, v11
    v_dot2c_f32_bf16 v36, v67, v11
    v_dot2c_f32_bf16 v37, v71, v11
    v_dot2c_f32_bf16 v38, v75, v11
    v_dot2c_f32_bf16 v39, v79, v11
    s_nop 2
    v_permlane16_swap_b32 v32, v33
    v_permlane16_swap_b32 v34, v35
    v_permlane16_swap_b32 v36, v37
    v_permlane16_swap_b32 v38, v39
    v_add_f32 v32, v32, v33
    v_add_f32 v34, v34, v35
    v_add_f32 v36, v36, v37
    v_add_f32 v38, v38, v39
    s_nop 0
    v_add_f32_dpp v32, v32, v32 row_ror:8 row_mask:0xf bank_mask:0x3
    v_add_f32_dpp v36, v36, v36 row_ror:8 row_mask:0xf bank_mask:0x3
    v_add_f32_dpp v32, v34, v34 row_ror:8 row_mask:0xf bank_mask:0xc
    v_add_f32_dpp v36, v38, v38 row_ror:8 row_mask:0xf bank_mask:0xc
    s_nop 1
    v_add_f32_dpp v32, v32, v32 row_shl:4 row_mask:0xf bank_mask:0x5
    s_nop 0
    v_add_f32_dpp v32, v36, v36 row_shr:4 row_mask:0xf bank_mask:0xa
    s_nop 1
    v_add_f32_dpp v32, v32, v32 quad_perm:[1,0,3,2] row_mask:0xf bank_mask:0xf
    s_nop 1
    v_add_f32_dpp v28, v32, v32 quad_perm:[2,3,0,1] row_mask:0xf bank_mask:0xf
    s_cmp_eq_u32 s10, 0
    s_cbranch_scc1 recurrent_scan__mha_block_cached__dense_activation_squared_relu__decode_kernel_k2
    s_cmp_eq_u32 s10, 3
    s_cbranch_scc1 recurrent_scan__mha_block_cached__dense_activation_squared_relu__decode_kernel_xv
    s_branch recurrent_scan__mha_block_cached__dense_activation_squared_relu__decode_kernel_sg2
recurrent_scan__mha_block_cached__dense_activation_squared_relu__decode_kernel_v1:
    s_waitcnt lgkmcnt(8)
    v_lshlrev_b32 v28, 16, v20
    v_and_b32 v29, 0xffff0000, v20
    v_mul_f32 v28, s44, v28
    v_mul_f32 v29, s44, v29
    v_max3_f32 v33, v28, v29, s11
    s_nop 1
    v_max_f32_dpp v33, v33, v33 row_ror:4 row_mask:0xf bank_mask:0xf
    s_nop 1
    v_max_f32_dpp v33, v33, v33 row_ror:8 row_mask:0xf bank_mask:0xf
    s_nop 1
    v_max_f32_dpp v33, v33, v33 row_bcast:15 row_mask:0xa bank_mask:0xf
    s_nop 1
    v_max_f32_dpp v33, v33, v33 row_bcast:31 row_mask:0xc bank_mask:0xf
    s_nop 0
    v_readlane_b32 s11, v33, 63
    s_nop 1
    v_subrev_f32 v32, s11, v28
    v_subrev_f32 v34, s11, v29
    v_subrev_f32 v33, s11, v17
    v_exp_f32 v32, v32
    v_exp_f32 v34, v34
    v_exp_f32 v33, v33
    v_mov_b32 v17, s11
    v_cvt_pk_bf16_f32 v18, v32, v32
    v_cvt_pk_bf16_f32 v249, v34, v34
    v_fma_f32 v16, v16, v33, v32
    v_mov_b32 v19, v18
    v_mov_b32 v250, v249
    v_add_f32 v16, v16, v34
    v_mul_f32 v12, v33, v12
    v_mul_f32 v13, v33, v13
    v_mul_f32 v14, v33, v14
    v_mul_f32 v15, v33, v15
    v_permlane16_swap_b32 v18, v19
    v_permlane16_swap_b32 v249, v250
    s_nop 0
    v_and_b32_dpp v40, v18, v4 row_newbcast:0 row_mask:0xf bank_mask:0xf
    v_and_b32_dpp v41, v18, v5 row_newbcast:0 row_mask:0xf bank_mask:0xf
    v_and_b32_dpp v42, v18, v6 row_newbcast:0 row_mask:0xf bank_mask:0xf
    v_and_b32_dpp v43, v18, v7 row_newbcast:0 row_mask:0xf bank_mask:0xf
    v_and_b32_dpp v44, v19, v4 row_newbcast:0 row_mask:0xf bank_mask:0xf
    v_and_b32_dpp v45, v19, v5 row_newbcast:0 row_mask:0xf bank_mask:0xf
    v_and_b32_dpp v46, v19, v6 row_newbcast:0 row_mask:0xf bank_mask:0xf
    v_and_b32_dpp v47, v19, v7 row_newbcast:0 row_mask:0xf bank_mask:0xf
    s_waitcnt lgkmcnt(7)
    v_mfma_f32_16x16x32_bf16 v[12:15], v[48:51], v[40:43], v[12:15]
    v_and_b32_dpp v40, v18, v4 row_newbcast:8 row_mask:0xf bank_mask:0xf
    v_and_b32_dpp v41, v18, v5 row_newbcast:8 row_mask:0xf bank_mask:0xf
    v_and_b32_dpp v42, v18, v6 row_newbcast:8 row_mask:0xf bank_mask:0xf
    v_and_b32_dpp v43, v18, v7 row_newbcast:8 row_mask:0xf bank_mask:0xf
    s_waitcnt lgkmcnt(6)
    v_mfma_f32_16x16x32_bf16 v[12:15], v[52:55], v[44:47], v[12:15]
    v_and_b32_dpp v44, v19, v4 row_newbcast:8 row_mask:0xf bank_mask:0xf
    v_and_b32_dpp v45, v19, v5 row_newbcast:8 row_mask:0xf bank_mask:0xf
    v_and_b32_dpp v46, v19, v6 row_newbcast:8 row_mask:0xf bank_mask:0xf
    v_and_b32_dpp v47, v19, v7 row_newbcast:8 row_mask:0xf bank_mask:0xf
    s_waitcnt lgkmcnt(5)
    v_mfma_f32_16x16x32_bf16 v[12:15], v[56:59], v[40:43], v[12:15]
    v_and_b32_dpp v40, v18, v4 row_newbcast:4 row_mask:0xf bank_mask:0xf
    v_and_b32_dpp v41, v18, v5 row_newbcast:4 row_mask:0xf bank_mask:0xf
    v_and_b32_dpp v42, v18, v6 row_newbcast:4 row_mask:0xf bank_mask:0xf
    v_and_b32_dpp v43, v18, v7 row_newbcast:4 row_mask:0xf bank_mask:0xf
    s_waitcnt lgkmcnt(4)
    v_mfma_f32_16x16x32_bf16 v[12:15], v[60:63], v[44:47], v[12:15]
    v_and_b32_dpp v44, v19, v4 row_newbcast:4 row_mask:0xf bank_mask:0xf
    v_and_b32_dpp v45, v19, v5 row_newbcast:4 row_mask:0xf bank_mask:0xf
    v_and_b32_dpp v46, v19, v6 row_newbcast:4 row_mask:0xf bank_mask:0xf
    v_and_b32_dpp v47, v19, v7 row_newbcast:4 row_mask:0xf bank_mask:0xf
    s_waitcnt lgkmcnt(3)
    v_mfma_f32_16x16x32_bf16 v[12:15], v[64:67], v[40:43], v[12:15]
    v_and_b32_dpp v40, v18, v4 row_newbcast:12 row_mask:0xf bank_mask:0xf
    v_and_b32_dpp v41, v18, v5 row_newbcast:12 row_mask:0xf bank_mask:0xf
    v_and_b32_dpp v42, v18, v6 row_newbcast:12 row_mask:0xf bank_mask:0xf
    v_and_b32_dpp v43, v18, v7 row_newbcast:12 row_mask:0xf bank_mask:0xf
    s_waitcnt lgkmcnt(2)
    v_mfma_f32_16x16x32_bf16 v[12:15], v[68:71], v[44:47], v[12:15]
    v_and_b32_dpp v44, v19, v4 row_newbcast:12 row_mask:0xf bank_mask:0xf
    v_and_b32_dpp v45, v19, v5 row_newbcast:12 row_mask:0xf bank_mask:0xf
    v_and_b32_dpp v46, v19, v6 row_newbcast:12 row_mask:0xf bank_mask:0xf
    v_and_b32_dpp v47, v19, v7 row_newbcast:12 row_mask:0xf bank_mask:0xf
    s_waitcnt lgkmcnt(1)
    v_mfma_f32_16x16x32_bf16 v[12:15], v[72:75], v[40:43], v[12:15]
    s_nop 1
    s_waitcnt lgkmcnt(0)
    v_mfma_f32_16x16x32_bf16 v[12:15], v[76:79], v[44:47], v[12:15]
recurrent_scan__mha_block_cached__dense_activation_squared_relu__decode_kernel_sg2:
    s_cmp_ge_u32 s57, 2
    s_cbranch_scc1 recurrent_scan__mha_block_cached__dense_activation_squared_relu__decode_kernel_wv16
    s_waitcnt vmcnt(0)
recurrent_scan__mha_block_cached__dense_activation_squared_relu__decode_kernel_wv16:
    s_waitcnt vmcnt(16)
    v_add_u32 v208, s9, v232
    ds_read_b128 v[80:83], v208 offset:8192
    ds_read_b128 v[84:87], v208 offset:9216
    ds_read_b128 v[88:91], v208 offset:10240
    ds_read_b128 v[92:95], v208 offset:11264
    ds_read_b128 v[96:99], v208 offset:12288
    ds_read_b128 v[100:103], v208 offset:13312
    ds_read_b128 v[104:107], v208 offset:14336
    ds_read_b128 v[108:111], v208 offset:15360
    s_cmp_lt_u32 s10, 11
    s_cbranch_scc1 recurrent_scan__mha_block_cached__dense_activation_squared_relu__decode_kernel_wold
recurrent_scan__mha_block_cached__dense_activation_squared_relu__decode_kernel_woret:
    s_cmp_lt_u32 s57, 3
    s_cbranch_scc1 recurrent_scan__mha_block_cached__dense_activation_squared_relu__decode_kernel_noiss
    s_cmp_ge_u32 s22, 14
    s_cbranch_scc1 recurrent_scan__mha_block_cached__dense_activation_squared_relu__decode_kernel_dyn
    s_cmp_ge_u32 s22, 7
    s_cselect_b32 s12, 7, 0
    s_cselect_b64 s[30:31], s[20:21], s[18:19]
    s_sub_u32 s55, s22, s12
    s_lshl_b32 s55, s55, 4
    s_add_u32 s55, s55, s100
    s_cmp_eq_u32 s22, 13
    s_cbranch_scc1 recurrent_scan__mha_block_cached__dense_activation_squared_relu__decode_kernel_claim
    s_branch recurrent_scan__mha_block_cached__dense_activation_squared_relu__decode_kernel_noclaim
recurrent_scan__mha_block_cached__dense_activation_squared_relu__decode_kernel_dyn:
    s_mov_b64 s[30:31], s[20:21]
    s_and_b32 s12, s22, 1
    s_cbranch_scc1 recurrent_scan__mha_block_cached__dense_activation_squared_relu__decode_kernel_claim
    v_readfirstlane_b32 s12, v237
    s_mov_b64 s[30:31], s[18:19]
    s_lshr_b32 s45, s12, 12
    s_and_b32 s12, s12, 0xfff
    s_cmp_lg_u32 s45, s96
    s_cselect_b32 s12, 0xfff, s12
    s_add_u32 s55, s12, 112
    s_cmp_lt_u32 s55, 128
    s_cbranch_scc1 recurrent_scan__mha_block_cached__dense_activation_squared_relu__decode_kernel_noclaim
    s_mov_b32 s42, s22
    s_branch recurrent_scan__mha_block_cached__dense_activation_squared_relu__decode_kernel_noiss
recurrent_scan__mha_block_cached__dense_activation_squared_relu__decode_kernel_claim:
    s_mov_b64 exec, 1
    global_atomic_add v237, v236, v238, s[26:27] sc0 sc1
    s_mov_b64 exec, -1
recurrent_scan__mha_block_cached__dense_activation_squared_relu__decode_kernel_noclaim:
    s_add_u32 s22, s22, 1
    s_add_u32 s6, s55, s48
    s_and_b32 s6, s6, 0x7f
    s_lshl_b32 s6, s6, 14
    s_add_u32 s4, s30, s6
    s_addc_u32 s5, s31, 0
    s_add_u32 s6, s4, 0x2000
    s_addc_u32 s7, s5, 0
    s_add_u32 m0, s8, s9
    s_nop 0
    global_load_lds_dwordx4 v2, s[4:5] offset:0 nt
    global_load_lds_dwordx4 v2, s[4:5] offset:1024 nt
    global_load_lds_dwordx4 v2, s[4:5] offset:2048 nt
    global_load_lds_dwordx4 v2, s[4:5] offset:3072 nt
    s_add_u32 m0, m0, 0x1000
    s_nop 0
    global_load_lds_dwordx4 v3, s[4:5] offset:0 nt
    global_load_lds_dwordx4 v3, s[4:5] offset:1024 nt
    global_load_lds_dwordx4 v3, s[4:5] offset:2048 nt
    global_load_lds_dwordx4 v3, s[4:5] offset:3072 nt
    s_add_u32 m0, m0, 0x1000
    s_waitcnt lgkmcnt(0)
    global_load_lds_dwordx4 v2, s[6:7] offset:0 nt
    global_load_lds_dwordx4 v2, s[6:7] offset:1024 nt
    global_load_lds_dwordx4 v2, s[6:7] offset:2048 nt
    global_load_lds_dwordx4 v2, s[6:7] offset:3072 nt
    s_add_u32 m0, m0, 0x1000
    s_nop 0
    global_load_lds_dwordx4 v3, s[6:7] offset:0 nt
    global_load_lds_dwordx4 v3, s[6:7] offset:1024 nt
    global_load_lds_dwordx4 v3, s[6:7] offset:2048 nt
    global_load_lds_dwordx4 v3, s[6:7] offset:3072 nt
recurrent_scan__mha_block_cached__dense_activation_squared_relu__decode_kernel_noiss:
    s_xor_b32 s9, s9, 0x4000
    s_cmp_lg_u32 s98, 0
    s_cbranch_scc1 recurrent_scan__mha_block_cached__dense_activation_squared_relu__decode_kernel_v2
    s_waitcnt lgkmcnt(0)
recurrent_scan__mha_block_cached__dense_activation_squared_relu__decode_kernel_k2:
    v_dot2_f32_bf16 v32, v80, v8, 0
    v_dot2_f32_bf16 v33, v84, v8, 0
    v_dot2_f32_bf16 v34, v88, v8, 0
    v_dot2_f32_bf16 v35, v92, v8, 0
    v_dot2_f32_bf16 v36, v96, v8, 0
    v_dot2_f32_bf16 v37, v100, v8, 0
    v_dot2_f32_bf16 v38, v104, v8, 0
    v_dot2_f32_bf16 v39, v108, v8, 0
    v_dot2c_f32_bf16 v32, v81, v9
    v_dot2c_f32_bf16 v33, v85, v9
    v_dot2c_f32_bf16 v34, v89, v9
    v_dot2c_f32_bf16 v35, v93, v9
    v_dot2c_f32_bf16 v36, v97, v9
    v_dot2c_f32_bf16 v37, v101, v9
    v_dot2c_f32_bf16 v38, v105, v9
    v_dot2c_f32_bf16 v39, v109, v9
    v_dot2c_f32_bf16 v32, v82, v10
    v_dot2c_f32_bf16 v33, v86, v10
    v_dot2c_f32_bf16 v34, v90, v10
    v_dot2c_f32_bf16 v35, v94, v10
    v_dot2c_f32_bf16 v36, v98, v10
    v_dot2c_f32_bf16 v37, v102, v10
    v_dot2c_f32_bf16 v38, v106, v10
    v_dot2c_f32_bf16 v39, v110, v10
    v_dot2c_f32_bf16 v32, v83, v11
    v_dot2c_f32_bf16 v33, v87, v11
    v_dot2c_f32_bf16 v34, v91, v11
    v_dot2c_f32_bf16 v35, v95, v11
    v_dot2c_f32_bf16 v36, v99, v11
    v_dot2c_f32_bf16 v37, v103, v11
    v_dot2c_f32_bf16 v38, v107, v11
    v_dot2c_f32_bf16 v39, v111, v11
    s_nop 2
    v_permlane16_swap_b32 v32, v33
    v_permlane16_swap_b32 v34, v35
    v_permlane16_swap_b32 v36, v37
    v_permlane16_swap_b32 v38, v39
    v_add_f32 v32, v32, v33
    v_add_f32 v34, v34, v35
    v_add_f32 v36, v36, v37
    v_add_f32 v38, v38, v39
    s_nop 0
    v_add_f32_dpp v32, v32, v32 row_ror:8 row_mask:0xf bank_mask:0x3
    v_add_f32_dpp v36, v36, v36 row_ror:8 row_mask:0xf bank_mask:0x3
    v_add_f32_dpp v32, v34, v34 row_ror:8 row_mask:0xf bank_mask:0xc
    v_add_f32_dpp v36, v38, v38 row_ror:8 row_mask:0xf bank_mask:0xc
    s_nop 1
    v_add_f32_dpp v32, v32, v32 row_shl:4 row_mask:0xf bank_mask:0x5
    s_nop 0
    v_add_f32_dpp v32, v36, v36 row_shr:4 row_mask:0xf bank_mask:0xa
    s_nop 1
    v_add_f32_dpp v32, v32, v32 quad_perm:[1,0,3,2] row_mask:0xf bank_mask:0xf
    s_nop 1
    v_add_f32_dpp v29, v32, v32 quad_perm:[2,3,0,1] row_mask:0xf bank_mask:0xf
    s_min_u32 s45, s10, 7
    s_lshl_b32 s45, s45, 6
    v_cvt_pk_bf16_f32 v20, v28, v29
    v_add_u32 v209, s45, v30
    ds_write_b32 v209, v20
    s_branch recurrent_scan__mha_block_cached__dense_activation_squared_relu__decode_kernel_next
recurrent_scan__mha_block_cached__dense_activation_squared_relu__decode_kernel_v2:
    v_and_b32_dpp v40, v249, v4 row_newbcast:0 row_mask:0xf bank_mask:0xf
    v_and_b32_dpp v41, v249, v5 row_newbcast:0 row_mask:0xf bank_mask:0xf
    v_and_b32_dpp v42, v249, v6 row_newbcast:0 row_mask:0xf bank_mask:0xf
    v_and_b32_dpp v43, v249, v7 row_newbcast:0 row_mask:0xf bank_mask:0xf
    v_and_b32_dpp v44, v250, v4 row_newbcast:0 row_mask:0xf bank_mask:0xf
    v_and_b32_dpp v45, v250, v5 row_newbcast:0 row_mask:0xf bank_mask:0xf
    v_and_b32_dpp v46, v250, v6 row_newbcast:0 row_mask:0xf bank_mask:0xf
    v_and_b32_dpp v47, v250, v7 row_newbcast:0 row_mask:0xf bank_mask:0xf
    s_waitcnt lgkmcnt(7)
    v_mfma_f32_16x16x32_bf16 v[12:15], v[80:83], v[40:43], v[12:15]
    v_and_b32_dpp v40, v249, v4 row_newbcast:8 row_mask:0xf bank_mask:0xf
    v_and_b32_dpp v41, v249, v5 row_newbcast:8 row_mask:0xf bank_mask:0xf
    v_and_b32_dpp v42, v249, v6 row_newbcast:8 row_mask:0xf bank_mask:0xf
    v_and_b32_dpp v43, v249, v7 row_newbcast:8 row_mask:0xf bank_mask:0xf
    s_waitcnt lgkmcnt(6)
    v_mfma_f32_16x16x32_bf16 v[12:15], v[84:87], v[44:47], v[12:15]
    v_and_b32_dpp v44, v250, v4 row_newbcast:8 row_mask:0xf bank_mask:0xf
    v_and_b32_dpp v45, v250, v5 row_newbcast:8 row_mask:0xf bank_mask:0xf
    v_and_b32_dpp v46, v250, v6 row_newbcast:8 row_mask:0xf bank_mask:0xf
    v_and_b32_dpp v47, v250, v7 row_newbcast:8 row_mask:0xf bank_mask:0xf
    s_waitcnt lgkmcnt(5)
    v_mfma_f32_16x16x32_bf16 v[12:15], v[88:91], v[40:43], v[12:15]
    v_and_b32_dpp v40, v249, v4 row_newbcast:4 row_mask:0xf bank_mask:0xf
    v_and_b32_dpp v41, v249, v5 row_newbcast:4 row_mask:0xf bank_mask:0xf
    v_and_b32_dpp v42, v249, v6 row_newbcast:4 row_mask:0xf bank_mask:0xf
    v_and_b32_dpp v43, v249, v7 row_newbcast:4 row_mask:0xf bank_mask:0xf
    s_waitcnt lgkmcnt(4)
    v_mfma_f32_16x16x32_bf16 v[12:15], v[92:95], v[44:47], v[12:15]
    v_and_b32_dpp v44, v250, v4 row_newbcast:4 row_mask:0xf bank_mask:0xf
    v_and_b32_dpp v45, v250, v5 row_newbcast:4 row_mask:0xf bank_mask:0xf
    v_and_b32_dpp v46, v250, v6 row_newbcast:4 row_mask:0xf bank_mask:0xf
    v_and_b32_dpp v47, v250, v7 row_newbcast:4 row_mask:0xf bank_mask:0xf
    s_waitcnt lgkmcnt(3)
    v_mfma_f32_16x16x32_bf16 v[12:15], v[96:99], v[40:43], v[12:15]
    v_and_b32_dpp v40, v249, v4 row_newbcast:12 row_mask:0xf bank_mask:0xf
    v_and_b32_dpp v41, v249, v5 row_newbcast:12 row_mask:0xf bank_mask:0xf
    v_and_b32_dpp v42, v249, v6 row_newbcast:12 row_mask:0xf bank_mask:0xf
    v_and_b32_dpp v43, v249, v7 row_newbcast:12 row_mask:0xf bank_mask:0xf
    s_waitcnt lgkmcnt(2)
    v_mfma_f32_16x16x32_bf16 v[12:15], v[100:103], v[44:47], v[12:15]
    v_and_b32_dpp v44, v250, v4 row_newbcast:12 row_mask:0xf bank_mask:0xf
    v_and_b32_dpp v45, v250, v5 row_newbcast:12 row_mask:0xf bank_mask:0xf
    v_and_b32_dpp v46, v250, v6 row_newbcast:12 row_mask:0xf bank_mask:0xf
    v_and_b32_dpp v47, v250, v7 row_newbcast:12 row_mask:0xf bank_mask:0xf
    s_waitcnt lgkmcnt(1)
    v_mfma_f32_16x16x32_bf16 v[12:15], v[104:107], v[40:43], v[12:15]
    s_nop 1
    s_waitcnt lgkmcnt(0)
    v_mfma_f32_16x16x32_bf16 v[12:15], v[108:111], v[44:47], v[12:15]
recurrent_scan__mha_block_cached__dense_activation_squared_relu__decode_kernel_next:
    s_add_u32 s10, s10, 1
recurrent_scan__mha_block_cached__dense_activation_squared_relu__decode_kernel_bswx:
    s_cmp_lt_u32 s10, s42
    s_cbranch_scc1 recurrent_scan__mha_block_cached__dense_activation_squared_relu__decode_kernel_loop
    s_branch recurrent_scan__mha_block_cached__dense_activation_squared_relu__decode_kernel_tail
recurrent_scan__mha_block_cached__dense_activation_squared_relu__decode_kernel_wold:
    s_cmp_lg_u32 s10, 1
    s_cbranch_scc1 recurrent_scan__mha_block_cached__dense_activation_squared_relu__decode_kernel_wo1
    s_add_u32 s45, s52, 0
    s_addc_u32 s46, s53, 0
    s_branch recurrent_scan__mha_block_cached__dense_activation_squared_relu__decode_kernel_woiss
recurrent_scan__mha_block_cached__dense_activation_squared_relu__decode_kernel_wo1:
    s_cmp_lg_u32 s10, 2
    s_cbranch_scc1 recurrent_scan__mha_block_cached__dense_activation_squared_relu__decode_kernel_wo2
    ds_read_b64_tr_b16 a[0:1], v207 offset:0
    ds_read_b64_tr_b16 a[2:3], v207 offset:896
    ds_read_b64_tr_b16 a[4:5], v207 offset:32
    ds_read_b64_tr_b16 a[6:7], v207 offset:928
    ds_read_b64_tr_b16 a[8:9], v207 offset:64
    ds_read_b64_tr_b16 a[10:11], v207 offset:960
    ds_read_b64_tr_b16 a[12:13], v207 offset:96
    ds_read_b64_tr_b16 a[14:15], v207 offset:992
    ds_read_b64_tr_b16 a[16:17], v207 offset:128
    ds_read_b64_tr_b16 a[18:19], v207 offset:1024
    ds_read_b64_tr_b16 a[20:21], v207 offset:160
    ds_read_b64_tr_b16 a[22:23], v207 offset:1056
    ds_read_b64_tr_b16 a[24:25], v207 offset:192
    ds_read_b64_tr_b16 a[26:27], v207 offset:1088
    s_add_u32 s45, s52, 114688
    s_addc_u32 s46, s53, 0
    s_branch recurrent_scan__mha_block_cached__dense_activation_squared_relu__decode_kernel_woiss
recurrent_scan__mha_block_cached__dense_activation_squared_relu__decode_kernel_wo2:
    s_cmp_lg_u32 s10, 4
    s_cbranch_scc1 recurrent_scan__mha_block_cached__dense_activation_squared_relu__decode_kernel_wo3
    ds_read_b64_tr_b16 a[28:29], v207 offset:0
    ds_read_b64_tr_b16 a[30:31], v207 offset:896
    ds_read_b64_tr_b16 a[32:33], v207 offset:32
    ds_read_b64_tr_b16 a[34:35], v207 offset:928
    ds_read_b64_tr_b16 a[36:37], v207 offset:64
    ds_read_b64_tr_b16 a[38:39], v207 offset:960
    ds_read_b64_tr_b16 a[40:41], v207 offset:96
    ds_read_b64_tr_b16 a[42:43], v207 offset:992
    ds_read_b64_tr_b16 a[44:45], v207 offset:128
    ds_read_b64_tr_b16 a[46:47], v207 offset:1024
    ds_read_b64_tr_b16 a[48:49], v207 offset:160
    ds_read_b64_tr_b16 a[50:51], v207 offset:1056
    ds_read_b64_tr_b16 a[52:53], v207 offset:192
    ds_read_b64_tr_b16 a[54:55], v207 offset:1088
    s_add_u32 s45, s52, 28672
    s_addc_u32 s46, s53, 0
    s_branch recurrent_scan__mha_block_cached__dense_activation_squared_relu__decode_kernel_woiss
recurrent_scan__mha_block_cached__dense_activation_squared_relu__decode_kernel_wo3:
    s_cmp_lg_u32 s10, 5
    s_cbranch_scc1 recurrent_scan__mha_block_cached__dense_activation_squared_relu__decode_kernel_wo4
    ds_read_b64_tr_b16 a[56:57], v207 offset:0
    ds_read_b64_tr_b16 a[58:59], v207 offset:896
    ds_read_b64_tr_b16 a[60:61], v207 offset:32
    ds_read_b64_tr_b16 a[62:63], v207 offset:928
    ds_read_b64_tr_b16 a[64:65], v207 offset:64
    ds_read_b64_tr_b16 a[66:67], v207 offset:960
    ds_read_b64_tr_b16 a[68:69], v207 offset:96
    ds_read_b64_tr_b16 a[70:71], v207 offset:992
    ds_read_b64_tr_b16 a[72:73], v207 offset:128
    ds_read_b64_tr_b16 a[74:75], v207 offset:1024
    ds_read_b64_tr_b16 a[76:77], v207 offset:160
    ds_read_b64_tr_b16 a[78:79], v207 offset:1056
    ds_read_b64_tr_b16 a[80:81], v207 offset:192
    ds_read_b64_tr_b16 a[82:83], v207 offset:1088
    s_add_u32 s45, s52, 143360
    s_addc_u32 s46, s53, 0
    s_branch recurrent_scan__mha_block_cached__dense_activation_squared_relu__decode_kernel_woiss
recurrent_scan__mha_block_cached__dense_activation_squared_relu__decode_kernel_wo4:
    s_cmp_lg_u32 s10, 6
    s_cbranch_scc1 recurrent_scan__mha_block_cached__dense_activation_squared_relu__decode_kernel_wo5
    ds_read_b64_tr_b16 a[84:85], v207 offset:0
    ds_read_b64_tr_b16 a[86:87], v207 offset:896
    ds_read_b64_tr_b16 a[88:89], v207 offset:32
    ds_read_b64_tr_b16 a[90:91], v207 offset:928
    ds_read_b64_tr_b16 a[92:93], v207 offset:64
    ds_read_b64_tr_b16 a[94:95], v207 offset:960
    ds_read_b64_tr_b16 a[96:97], v207 offset:96
    ds_read_b64_tr_b16 a[98:99], v207 offset:992
    ds_read_b64_tr_b16 a[100:101], v207 offset:128
    ds_read_b64_tr_b16 a[102:103], v207 offset:1024
    ds_read_b64_tr_b16 a[104:105], v207 offset:160
    ds_read_b64_tr_b16 a[106:107], v207 offset:1056
    ds_read_b64_tr_b16 a[108:109], v207 offset:192
    ds_read_b64_tr_b16 a[110:111], v207 offset:1088
    s_add_u32 s45, s52, 57344
    s_addc_u32 s46, s53, 0
    s_branch recurrent_scan__mha_block_cached__dense_activation_squared_relu__decode_kernel_woiss
recurrent_scan__mha_block_cached__dense_activation_squared_relu__decode_kernel_wo5:
    s_cmp_lg_u32 s10, 7
    s_cbranch_scc1 recurrent_scan__mha_block_cached__dense_activation_squared_relu__decode_kernel_wo6
    ds_read_b64_tr_b16 a[112:113], v207 offset:0
    ds_read_b64_tr_b16 a[114:115], v207 offset:896
    ds_read_b64_tr_b16 a[116:117], v207 offset:32
    ds_read_b64_tr_b16 a[118:119], v207 offset:928
    ds_read_b64_tr_b16 a[120:121], v207 offset:64
    ds_read_b64_tr_b16 a[122:123], v207 offset:960
    ds_read_b64_tr_b16 a[124:125], v207 offset:96
    ds_read_b64_tr_b16 a[126:127], v207 offset:992
    ds_read_b64_tr_b16 a[128:129], v207 offset:128
    ds_read_b64_tr_b16 a[130:131], v207 offset:1024
    ds_read_b64_tr_b16 a[132:133], v207 offset:160
    ds_read_b64_tr_b16 a[134:135], v207 offset:1056
    ds_read_b64_tr_b16 a[136:137], v207 offset:192
    ds_read_b64_tr_b16 a[138:139], v207 offset:1088
    s_add_u32 s45, s52, 172032
    s_addc_u32 s46, s53, 0
    s_branch recurrent_scan__mha_block_cached__dense_activation_squared_relu__decode_kernel_woiss
recurrent_scan__mha_block_cached__dense_activation_squared_relu__decode_kernel_wo6:
    s_cmp_lg_u32 s10, 8
    s_cbranch_scc1 recurrent_scan__mha_block_cached__dense_activation_squared_relu__decode_kernel_wo7
    ds_read_b64_tr_b16 a[140:141], v207 offset:0
    ds_read_b64_tr_b16 a[142:143], v207 offset:896
    ds_read_b64_tr_b16 a[144:145], v207 offset:32
    ds_read_b64_tr_b16 a[146:147], v207 offset:928
    ds_read_b64_tr_b16 a[148:149], v207 offset:64
    ds_read_b64_tr_b16 a[150:151], v207 offset:960
    ds_read_b64_tr_b16 a[152:153], v207 offset:96
    ds_read_b64_tr_b16 a[154:155], v207 offset:992
    ds_read_b64_tr_b16 a[156:157], v207 offset:128
    ds_read_b64_tr_b16 a[158:159], v207 offset:1024
    ds_read_b64_tr_b16 a[160:161], v207 offset:160
    ds_read_b64_tr_b16 a[162:163], v207 offset:1056
    ds_read_b64_tr_b16 a[164:165], v207 offset:192
    ds_read_b64_tr_b16 a[166:167], v207 offset:1088
    s_add_u32 s45, s52, 86016
    s_addc_u32 s46, s53, 0
    s_branch recurrent_scan__mha_block_cached__dense_activation_squared_relu__decode_kernel_woiss
recurrent_scan__mha_block_cached__dense_activation_squared_relu__decode_kernel_wo7:
    s_cmp_lg_u32 s10, 9
    s_cbranch_scc1 recurrent_scan__mha_block_cached__dense_activation_squared_relu__decode_kernel_wo8
    ds_read_b64_tr_b16 a[168:169], v207 offset:0
    ds_read_b64_tr_b16 a[170:171], v207 offset:896
    ds_read_b64_tr_b16 a[172:173], v207 offset:32
    ds_read_b64_tr_b16 a[174:175], v207 offset:928
    ds_read_b64_tr_b16 a[176:177], v207 offset:64
    ds_read_b64_tr_b16 a[178:179], v207 offset:960
    ds_read_b64_tr_b16 a[180:181], v207 offset:96
    ds_read_b64_tr_b16 a[182:183], v207 offset:992
    ds_read_b64_tr_b16 a[184:185], v207 offset:128
    ds_read_b64_tr_b16 a[186:187], v207 offset:1024
    ds_read_b64_tr_b16 a[188:189], v207 offset:160
    ds_read_b64_tr_b16 a[190:191], v207 offset:1056
    ds_read_b64_tr_b16 a[192:193], v207 offset:192
    ds_read_b64_tr_b16 a[194:195], v207 offset:1088
    s_add_u32 s45, s52, 200704
    s_addc_u32 s46, s53, 0
    s_branch recurrent_scan__mha_block_cached__dense_activation_squared_relu__decode_kernel_woiss
recurrent_scan__mha_block_cached__dense_activation_squared_relu__decode_kernel_wo8:
    ds_read_b64_tr_b16 a[196:197], v207 offset:0
    ds_read_b64_tr_b16 a[198:199], v207 offset:896
    ds_read_b64_tr_b16 a[200:201], v207 offset:32
    ds_read_b64_tr_b16 a[202:203], v207 offset:928
    ds_read_b64_tr_b16 a[204:205], v207 offset:64
    ds_read_b64_tr_b16 a[206:207], v207 offset:960
    ds_read_b64_tr_b16 a[208:209], v207 offset:96
    ds_read_b64_tr_b16 a[210:211], v207 offset:992
    ds_read_b64_tr_b16 a[212:213], v207 offset:128
    ds_read_b64_tr_b16 a[214:215], v207 offset:1024
    ds_read_b64_tr_b16 a[216:217], v207 offset:160
    ds_read_b64_tr_b16 a[218:219], v207 offset:1056
    ds_read_b64_tr_b16 a[220:221], v207 offset:192
    ds_read_b64_tr_b16 a[222:223], v207 offset:1088
    s_branch recurrent_scan__mha_block_cached__dense_activation_squared_relu__decode_kernel_woret
recurrent_scan__mha_block_cached__dense_activation_squared_relu__decode_kernel_woiss:
    s_mov_b32 s4, s45
    s_mov_b32 s5, s46
    s_mov_b32 m0, s50
    s_waitcnt lgkmcnt(0)
    global_load_lds_dwordx4 v200, s[4:5]
    s_add_u32 m0, m0, 0x400
    s_nop 0
    global_load_lds_dwordx4 v201, s[4:5]
    s_add_u32 m0, m0, 0x400
    s_nop 0
    global_load_lds_dwordx4 v202, s[4:5]
    s_add_u32 m0, m0, 0x400
    s_nop 0
    global_load_lds_dwordx4 v203, s[4:5]
    s_add_u32 m0, m0, 0x400
    s_nop 0
    global_load_lds_dwordx4 v204, s[4:5]
    s_add_u32 m0, m0, 0x400
    s_nop 0
    global_load_lds_dwordx4 v205, s[4:5]
    s_add_u32 m0, m0, 0x400
    s_nop 0
    global_load_lds_dwordx4 v206, s[4:5]
    s_branch recurrent_scan__mha_block_cached__dense_activation_squared_relu__decode_kernel_woret
recurrent_scan__mha_block_cached__dense_activation_squared_relu__decode_kernel_xk:
    v_mov_b32 v48, v112
    v_mov_b32 v49, v113
    v_mov_b32 v50, v114
    v_mov_b32 v51, v115
    v_mov_b32 v52, v116
    v_mov_b32 v53, v117
    v_mov_b32 v54, v118
    v_mov_b32 v55, v119
    v_mov_b32 v56, v120
    v_mov_b32 v57, v121
    v_mov_b32 v58, v122
    v_mov_b32 v59, v123
    v_mov_b32 v60, v124
    v_mov_b32 v61, v125
    v_mov_b32 v62, v126
    v_mov_b32 v63, v127
    v_mov_b32 v64, v128
    v_mov_b32 v65, v129
    v_mov_b32 v66, v130
    v_mov_b32 v67, v131
    v_mov_b32 v68, v132
    v_mov_b32 v69, v133
    v_mov_b32 v70, v134
    v_mov_b32 v71, v135
    v_mov_b32 v72, v136
    v_mov_b32 v73, v137
    v_mov_b32 v74, v138
    v_mov_b32 v75, v139
    v_mov_b32 v76, v140
    v_mov_b32 v77, v141
    v_mov_b32 v78, v142
    v_mov_b32 v79, v143
    s_branch recurrent_scan__mha_block_cached__dense_activation_squared_relu__decode_kernel_k1
recurrent_scan__mha_block_cached__dense_activation_squared_relu__decode_kernel_xv:
    s_waitcnt vmcnt(32)
    v_mov_b32 v80, v144
    v_mov_b32 v81, v145
    v_mov_b32 v82, v146
    v_mov_b32 v83, v147
    v_mov_b32 v84, v148
    v_mov_b32 v85, v149
    v_mov_b32 v86, v150
    v_mov_b32 v87, v151
    v_mov_b32 v88, v152
    v_mov_b32 v89, v153
    v_mov_b32 v90, v154
    v_mov_b32 v91, v155
    v_mov_b32 v92, v156
    v_mov_b32 v93, v157
    v_mov_b32 v94, v158
    v_mov_b32 v95, v159
    v_mov_b32 v96, v160
    v_mov_b32 v97, v161
    v_mov_b32 v98, v162
    v_mov_b32 v99, v163
    v_mov_b32 v100, v164
    v_mov_b32 v101, v165
    v_mov_b32 v102, v166
    v_mov_b32 v103, v167
    v_mov_b32 v104, v168
    v_mov_b32 v105, v169
    v_mov_b32 v106, v170
    v_mov_b32 v107, v171
    v_mov_b32 v108, v172
    v_mov_b32 v109, v173
    v_mov_b32 v110, v174
    v_mov_b32 v111, v175
    s_branch recurrent_scan__mha_block_cached__dense_activation_squared_relu__decode_kernel_k2
recurrent_scan__mha_block_cached__dense_activation_squared_relu__decode_kernel_tail:
    s_nop 1
    v_add_f32_dpp v16, v16, v16 row_ror:8 row_mask:0xf bank_mask:0xf
    s_nop 1
    v_add_f32_dpp v16, v16, v16 row_ror:4 row_mask:0xf bank_mask:0xf
    s_nop 1
    v_add_f32_dpp v16, v16, v16 row_bcast:15 row_mask:0xa bank_mask:0xf
    s_nop 1
    v_add_f32_dpp v16, v16, v16 row_bcast:31 row_mask:0xc bank_mask:0xf
    v_cvt_pk_bf16_f32 v12, v12, v13
    v_cvt_pk_bf16_f32 v13, v14, v15
    s_lshl_b32 s12, s3, 3
    s_add_u32 s12, s12, 159808
    v_mov_b32 v208, s12
    ds_write_b64 v239, v[12:13] offset:0
    s_mov_b32 exec_lo, 0
    s_mov_b32 exec_hi, 0x80000000
    ds_write_b64 v208, v[16:17] offset:0
    s_mov_b64 exec, -1
    s_cmp_ge_u32 s2, 28
    s_cbranch_scc1 recurrent_scan__mha_block_cached__dense_activation_squared_relu__decode_kernel_nocons0
    v_mov_b32 v124, 0
    v_mov_b32 v125, v235
    v_mov_b32 v126, 0
    v_mov_b32 v127, v235
    global_load_dwordx4 v[112:115], v2, s[62:63] offset:0 sc1
    global_load_dwordx4 v[116:119], v2, s[62:63] offset:1024 sc1
    global_load_dwordx4 v[120:123], v2, s[62:63] offset:2048 sc1
    s_mov_b32 exec_hi, 0
    global_load_dwordx4 v[124:127], v2, s[62:63] offset:3072 sc1
    s_mov_b64 exec, -1
    global_load_ushort v246, v245, s[16:17]
    global_load_ushort v247, v244, s[34:35]
recurrent_scan__mha_block_cached__dense_activation_squared_relu__decode_kernel_nocons0:
    v_mov_b32 v210, 0
    v_lshlrev_b32 v208, 5, v210
    v_add_u32 v208, 159808, v208
    s_lshl_b32 s45, s51, 4
    s_add_u32 s45, s45, 131072
    v_lshlrev_b32 v209, 12, v210
    v_add_u32 v209, s45, v209
    s_mov_b32 s45, 0x4000
    s_mul_i32 s46, s14, 7168
    v_lshl_add_u32 v209, v1, 10, v209
    v_add_u32 v209, s46, v209
    v_mov_b32 v213, v235
    v_mov_b32 v215, v235
    s_waitcnt lgkmcnt(0)
    s_barrier
    ds_read_b128 v[216:219], v208
    ds_read_b128 v[220:223], v208 offset:16
    ds_read_b128 v[48:51], v240 offset:0
    ds_read_b128 v[52:55], v240 offset:64
    ds_read_b128 v[56:59], v240 offset:128
    ds_read_b128 v[60:63], v240 offset:192
    ds_read_b128 v[64:67], v240 offset:256
    ds_read_b128 v[68:71], v240 offset:320
    ds_read_b128 v[72:75], v240 offset:384
    ds_read_b128 v[76:79], v240 offset:448
    s_waitcnt lgkmcnt(7)
    v_mfma_f32_16x16x32_bf16 v[80:83], v[48:51], a[0:3], 0
    v_max3_f32 v212, v217, v219, v221
    v_max_f32 v212, v212, v223
    s_waitcnt lgkmcnt(6)
    v_mfma_f32_16x16x32_bf16 v[80:83], v[52:55], a[28:31], v[80:83]
    v_sub_f32 v217, v217, v212
    v_sub_f32 v219, v219, v212
    s_waitcnt lgkmcnt(5)
    v_mfma_f32_16x16x32_bf16 v[80:83], v[56:59], a[56:59], v[80:83]
    v_sub_f32 v221, v221, v212
    v_sub_f32 v223, v223, v212
    s_waitcnt lgkmcnt(4)
    v_mfma_f32_16x16x32_bf16 v[80:83], v[60:63], a[84:87], v[80:83]
    v_exp_f32 v217, v217
    v_exp_f32 v219, v219
    s_waitcnt lgkmcnt(3)
    v_mfma_f32_16x16x32_bf16 v[80:83], v[64:67], a[112:115], v[80:83]
    v_exp_f32 v221, v221
    v_exp_f32 v223, v223
    s_waitcnt lgkmcnt(2)
    v_mfma_f32_16x16x32_bf16 v[80:83], v[68:71], a[140:143], v[80:83]
    v_mul_f32 v214, v216, v217
    v_fmac_f32 v214, v218, v219
    s_waitcnt lgkmcnt(1)
    v_mfma_f32_16x16x32_bf16 v[80:83], v[72:75], a[168:171], v[80:83]
    v_fmac_f32 v214, v220, v221
    v_fmac_f32 v214, v222, v223
    s_waitcnt lgkmcnt(0)
    v_mfma_f32_16x16x32_bf16 v[80:83], v[76:79], a[196:199], v[80:83]
    v_mfma_f32_16x16x32_bf16 v[84:87], v[48:51], a[4:7], 0
    s_cmp_lg_u32 s3, 0
    s_cbranch_scc1 recurrent_scan__mha_block_cached__dense_activation_squared_relu__decode_kernel_noml
    s_mov_b32 exec_lo, 0x7f
    s_mov_b32 exec_hi, 0
    global_store_dwordx4 v209, v[212:215], s[40:41] sc1
    s_mov_b64 exec, -1
recurrent_scan__mha_block_cached__dense_activation_squared_relu__decode_kernel_noml:
    v_mfma_f32_16x16x32_bf16 v[84:87], v[52:55], a[32:35], v[84:87]
    v_mov_b32 v41, v235
    v_mfma_f32_16x16x32_bf16 v[84:87], v[56:59], a[60:63], v[84:87]
    v_mov_b32 v43, v235
    v_mfma_f32_16x16x32_bf16 v[84:87], v[60:63], a[88:91], v[84:87]
    v_mov_b32 v45, v235
    v_mfma_f32_16x16x32_bf16 v[84:87], v[64:67], a[116:119], v[84:87]
    v_mov_b32 v47, v235
    v_mfma_f32_16x16x32_bf16 v[84:87], v[68:71], a[144:147], v[84:87]
    v_mfma_f32_16x16x32_bf16 v[84:87], v[72:75], a[172:175], v[84:87]
    v_mfma_f32_16x16x32_bf16 v[84:87], v[76:79], a[200:203], v[84:87]
    v_mfma_f32_16x16x32_bf16 v[88:91], v[48:51], a[8:11], 0
    v_mul_f32 v80, v80, v217
    v_mfma_f32_16x16x32_bf16 v[88:91], v[52:55], a[36:39], v[88:91]
    v_fmac_f32 v80, v81, v219
    v_mfma_f32_16x16x32_bf16 v[88:91], v[56:59], a[64:67], v[88:91]
    v_fmac_f32 v80, v82, v221
    v_mfma_f32_16x16x32_bf16 v[88:91], v[60:63], a[92:95], v[88:91]
    v_fmac_f32 v80, v83, v223
    v_mfma_f32_16x16x32_bf16 v[88:91], v[64:67], a[120:123], v[88:91]
    s_nop 1
    v_mfma_f32_16x16x32_bf16 v[88:91], v[68:71], a[148:151], v[88:91]
    v_mov_b32_dpp v40, v80 quad_perm:[0,1,2,3] row_mask:0x1 bank_mask:0xf
    v_mfma_f32_16x16x32_bf16 v[88:91], v[72:75], a[176:179], v[88:91]
    v_mov_b32_dpp v42, v80 quad_perm:[1,0,3,2] row_mask:0x1 bank_mask:0xf
    v_mfma_f32_16x16x32_bf16 v[88:91], v[76:79], a[204:207], v[88:91]
    v_mfma_f32_16x16x32_bf16 v[92:95], v[48:51], a[12:15], 0
    v_mul_f32 v84, v84, v217
    v_mfma_f32_16x16x32_bf16 v[92:95], v[52:55], a[40:43], v[92:95]
    v_fmac_f32 v84, v85, v219
    v_mfma_f32_16x16x32_bf16 v[92:95], v[56:59], a[68:71], v[92:95]
    v_fmac_f32 v84, v86, v221
    v_mfma_f32_16x16x32_bf16 v[92:95], v[60:63], a[96:99], v[92:95]
    v_fmac_f32 v84, v87, v223
    v_mfma_f32_16x16x32_bf16 v[92:95], v[64:67], a[124:127], v[92:95]
    s_nop 1
    v_mfma_f32_16x16x32_bf16 v[92:95], v[68:71], a[152:155], v[92:95]
    v_mov_b32_dpp v40, v84 quad_perm:[0,1,2,3] row_mask:0x2 bank_mask:0xf
    v_mfma_f32_16x16x32_bf16 v[92:95], v[72:75], a[180:183], v[92:95]
    v_mov_b32_dpp v42, v84 quad_perm:[1,0,3,2] row_mask:0x2 bank_mask:0xf
    v_mfma_f32_16x16x32_bf16 v[92:95], v[76:79], a[208:211], v[92:95]
    v_mfma_f32_16x16x32_bf16 v[96:99], v[48:51], a[16:19], 0
    v_mul_f32 v88, v88, v217
    v_mfma_f32_16x16x32_bf16 v[96:99], v[52:55], a[44:47], v[96:99]
    v_fmac_f32 v88, v89, v219
    v_mfma_f32_16x16x32_bf16 v[96:99], v[56:59], a[72:75], v[96:99]
    v_fmac_f32 v88, v90, v221
    v_mfma_f32_16x16x32_bf16 v[96:99], v[60:63], a[100:103], v[96:99]
    v_fmac_f32 v88, v91, v223
    v_mfma_f32_16x16x32_bf16 v[96:99], v[64:67], a[128:131], v[96:99]
    s_nop 1
    v_mfma_f32_16x16x32_bf16 v[96:99], v[68:71], a[156:159], v[96:99]
    v_mov_b32_dpp v40, v88 quad_perm:[0,1,2,3] row_mask:0x4 bank_mask:0xf
    v_mfma_f32_16x16x32_bf16 v[96:99], v[72:75], a[184:187], v[96:99]
    v_mov_b32_dpp v42, v88 quad_perm:[1,0,3,2] row_mask:0x4 bank_mask:0xf
    v_mfma_f32_16x16x32_bf16 v[96:99], v[76:79], a[212:215], v[96:99]
    v_mfma_f32_16x16x32_bf16 v[100:103], v[48:51], a[20:23], 0
    v_mul_f32 v92, v92, v217
    v_mfma_f32_16x16x32_bf16 v[100:103], v[52:55], a[48:51], v[100:103]
    v_fmac_f32 v92, v93, v219
    v_mfma_f32_16x16x32_bf16 v[100:103], v[56:59], a[76:79], v[100:103]
    v_fmac_f32 v92, v94, v221
    v_mfma_f32_16x16x32_bf16 v[100:103], v[60:63], a[104:107], v[100:103]
    v_fmac_f32 v92, v95, v223
    v_mfma_f32_16x16x32_bf16 v[100:103], v[64:67], a[132:135], v[100:103]
    s_nop 1
    v_mfma_f32_16x16x32_bf16 v[100:103], v[68:71], a[160:163], v[100:103]
    v_mov_b32_dpp v40, v92 quad_perm:[0,1,2,3] row_mask:0x8 bank_mask:0xf
    v_mfma_f32_16x16x32_bf16 v[100:103], v[72:75], a[188:191], v[100:103]
    v_mov_b32_dpp v42, v92 quad_perm:[1,0,3,2] row_mask:0x8 bank_mask:0xf
    v_mfma_f32_16x16x32_bf16 v[100:103], v[76:79], a[216:219], v[100:103]
    v_cvt_pk_bf16_f32 v40, v40, v42
    s_mov_b32 vcc_lo, 0x11111111
    s_mov_b32 vcc_hi, 0x11111111
    v_mov_b32_dpp v42, v40 quad_perm:[2,2,2,2] row_mask:0xf bank_mask:0xf
    s_mov_b64 exec, vcc
    global_store_dwordx4 v241, v[40:43], s[40:41] sc1
    s_mov_b64 exec, -1
    v_add_u32 v241, s45, v241
    v_mfma_f32_16x16x32_bf16 v[104:107], v[48:51], a[24:27], 0
    v_mul_f32 v96, v96, v217
    v_mfma_f32_16x16x32_bf16 v[104:107], v[52:55], a[52:55], v[104:107]
    v_fmac_f32 v96, v97, v219
    v_mfma_f32_16x16x32_bf16 v[104:107], v[56:59], a[80:83], v[104:107]
    v_fmac_f32 v96, v98, v221
    v_mfma_f32_16x16x32_bf16 v[104:107], v[60:63], a[108:111], v[104:107]
    v_fmac_f32 v96, v99, v223
    v_mfma_f32_16x16x32_bf16 v[104:107], v[64:67], a[136:139], v[104:107]
    s_nop 1
    v_mfma_f32_16x16x32_bf16 v[104:107], v[68:71], a[164:167], v[104:107]
    v_mov_b32_dpp v44, v96 quad_perm:[0,1,2,3] row_mask:0x1 bank_mask:0xf
    v_mfma_f32_16x16x32_bf16 v[104:107], v[72:75], a[192:195], v[104:107]
    v_mov_b32_dpp v46, v96 quad_perm:[1,0,3,2] row_mask:0x1 bank_mask:0xf
    v_mfma_f32_16x16x32_bf16 v[104:107], v[76:79], a[220:223], v[104:107]
    v_mul_f32 v100, v100, v217
    v_fmac_f32 v100, v101, v219
    v_fmac_f32 v100, v102, v221
    v_fmac_f32 v100, v103, v223
    s_nop 1
    v_mov_b32_dpp v44, v100 quad_perm:[0,1,2,3] row_mask:0x2 bank_mask:0xf
    v_mov_b32_dpp v46, v100 quad_perm:[1,0,3,2] row_mask:0x2 bank_mask:0xf
    s_nop 0
    v_mul_f32 v104, v104, v217
    v_fmac_f32 v104, v105, v219
    v_fmac_f32 v104, v106, v221
    v_fmac_f32 v104, v107, v223
    s_nop 1
    v_mov_b32_dpp v44, v104 quad_perm:[0,1,2,3] row_mask:0x4 bank_mask:0xf
    v_mov_b32_dpp v46, v104 quad_perm:[1,0,3,2] row_mask:0x4 bank_mask:0xf
    v_cvt_pk_bf16_f32 v44, v44, v46
    s_mov_b32 vcc_lo, 0x11111111
    s_mov_b32 vcc_hi, 0x1111
    v_mov_b32_dpp v46, v44 quad_perm:[2,2,2,2] row_mask:0xf bank_mask:0xf
    s_mov_b64 exec, vcc
    global_store_dwordx4 v241, v[44:47], s[40:41] sc1
    s_mov_b64 exec, -1
    v_add_u32 v241, s45, v241
recurrent_scan__mha_block_cached__dense_activation_squared_relu__decode_kernel_fin:
    s_cmp_ge_u32 s2, 28
    s_cbranch_scc1 recurrent_scan__mha_block_cached__dense_activation_squared_relu__decode_kernel_done
    global_load_dwordx4 v[216:219], v242, s[40:41] offset:0 sc1
    s_waitcnt vmcnt(1)
recurrent_scan__mha_block_cached__dense_activation_squared_relu__decode_kernel_zchk:
    v_xor_b32 v32, v113, v235
    v_bitop3_b32 v32, v32, v115, v235 bitop3:0xf6
    v_bitop3_b32 v32, v32, v117, v235 bitop3:0xf6
    v_bitop3_b32 v32, v32, v119, v235 bitop3:0xf6
    v_bitop3_b32 v32, v32, v121, v235 bitop3:0xf6
    v_bitop3_b32 v32, v32, v123, v235 bitop3:0xf6
    v_bitop3_b32 v32, v32, v125, v235 bitop3:0xf6
    v_bitop3_b32 v32, v32, v127, v235 bitop3:0xf6
    v_cmp_ne_u32 vcc, 0, v32
    s_add_u32 s56, s56, 1
    s_cmp_gt_u32 s56, 262144
    s_cbranch_vccz recurrent_scan__mha_block_cached__dense_activation_squared_relu__decode_kernel_zok
    s_cbranch_scc1 recurrent_scan__mha_block_cached__dense_activation_squared_relu__decode_kernel_zok
    global_load_dwordx4 v[112:115], v2, s[62:63] offset:0 sc1
    global_load_dwordx4 v[116:119], v2, s[62:63] offset:1024 sc1
    global_load_dwordx4 v[120:123], v2, s[62:63] offset:2048 sc1
    s_mov_b32 exec_hi, 0
    global_load_dwordx4 v[124:127], v2, s[62:63] offset:3072 sc1
    s_mov_b64 exec, -1
    s_waitcnt vmcnt(0)
    s_branch recurrent_scan__mha_block_cached__dense_activation_squared_relu__decode_kernel_zchk
recurrent_scan__mha_block_cached__dense_activation_squared_relu__decode_kernel_zok:
    v_and_b32 v113, 0xffff0000, v112
    v_lshlrev_b32 v112, 16, v112
    v_and_b32 v115, 0xffff0000, v114
    v_lshlrev_b32 v114, 16, v114
    v_and_b32 v117, 0xffff0000, v116
    v_lshlrev_b32 v116, 16, v116
    v_and_b32 v119, 0xffff0000, v118
    v_lshlrev_b32 v118, 16, v118
    v_and_b32 v121, 0xffff0000, v120
    v_lshlrev_b32 v120, 16, v120
    v_and_b32 v123, 0xffff0000, v122
    v_lshlrev_b32 v122, 16, v122
    v_and_b32 v125, 0xffff0000, v124
    v_lshlrev_b32 v124, 16, v124
    v_and_b32 v127, 0xffff0000, v126
    v_lshlrev_b32 v126, 16, v126
    v_add_f32 v112, v112, v116
    v_add_f32 v120, v120, v124
    v_add_f32 v113, v113, v117
    v_add_f32 v121, v121, v125
    v_add_f32 v114, v114, v118
    v_add_f32 v122, v122, v126
    v_add_f32 v115, v115, v119
    v_add_f32 v123, v123, v127
    v_add_f32 v112, v112, v120
    v_add_f32 v113, v113, v121
    v_add_f32 v114, v114, v122
    v_add_f32 v115, v115, v123
    s_nop 1
    v_permlane32_swap_b32 v112, v113
    v_permlane32_swap_b32 v114, v115
    v_add_f32 v112, v112, v113
    v_add_f32 v114, v114, v115
    s_nop 1
    v_permlane16_swap_b32 v112, v114
    v_add_f32 v112, v112, v114
    s_nop 1
    v_add_f32_dpp v112, v112, v112 row_ror:4 row_mask:0xf bank_mask:0xf
    s_nop 1
    v_add_f32_dpp v112, v112, v112 row_ror:8 row_mask:0xf bank_mask:0xf
    v_lshlrev_b32 v246, 16, v246
    v_lshlrev_b32 v247, 16, v247
    v_cvt_pk_bf16_f32 v248, v112, v112
    v_lshlrev_b32 v248, 16, v248
    v_add_f32 v248, v248, v247
    v_cvt_pk_bf16_f32 v248, v248, v248
    v_lshlrev_b32 v248, 16, v248
    v_mul_f32 v37, 0xbfb8aa3b, v248
    v_exp_f32 v37, v37
    s_nop 0
    v_add_f32 v37, 1.0, v37
    v_rcp_f32 v37, v37
    s_nop 0
    v_mul_f32 v248, v248, v37
    v_cvt_pk_bf16_f32 v248, v248, v248
    v_lshlrev_b32 v248, 16, v248
recurrent_scan__mha_block_cached__dense_activation_squared_relu__decode_kernel_mlw:
    s_waitcnt vmcnt(0)
    v_xor_b32 v32, v217, v235
    v_bitop3_b32 v32, v32, v219, v235 bitop3:0xf6
    v_cmp_ne_u32 vcc, 0, v32
    s_add_u32 s56, s56, 1
    s_cmp_gt_u32 s56, 262144
    s_cbranch_vccz recurrent_scan__mha_block_cached__dense_activation_squared_relu__decode_kernel_mlok
    s_cbranch_scc1 recurrent_scan__mha_block_cached__dense_activation_squared_relu__decode_kernel_mlok
    global_load_dwordx4 v[216:219], v242, s[40:41] offset:0 sc1
    s_branch recurrent_scan__mha_block_cached__dense_activation_squared_relu__decode_kernel_mlw
recurrent_scan__mha_block_cached__dense_activation_squared_relu__decode_kernel_mlok:
    global_load_dwordx4 v[128:131], v2, s[60:61] offset:0 sc1
    global_load_dwordx4 v[132:135], v2, s[60:61] offset:1024 sc1
    global_load_dwordx4 v[136:139], v2, s[60:61] offset:2048 sc1
    global_load_dwordx4 v[140:143], v2, s[60:61] offset:3072 sc1
    v_max_f32_dpp v217, v216, v216 quad_perm:[1,0,3,2] row_mask:0xf bank_mask:0xf
    s_nop 1
    v_max_f32_dpp v217, v217, v217 quad_perm:[2,3,0,1] row_mask:0xf bank_mask:0xf
    v_sub_f32 v216, v216, v217
    v_exp_f32 v216, v216
    s_nop 0
    v_mul_f32 v218, v218, v216
    s_nop 1
    v_add_f32_dpp v218, v218, v218 quad_perm:[1,0,3,2] row_mask:0xf bank_mask:0xf
    s_nop 1
    v_add_f32_dpp v218, v218, v218 quad_perm:[2,3,0,1] row_mask:0xf bank_mask:0xf
    v_rcp_f32 v218, v218
    s_nop 0
    v_mul_f32 v216, v216, v218
    ds_bpermute_b32 v112, v243, v216 offset:0
    ds_bpermute_b32 v113, v243, v216 offset:64
    ds_bpermute_b32 v114, v243, v216 offset:128
    ds_bpermute_b32 v115, v243, v216 offset:192
    s_waitcnt lgkmcnt(0)
recurrent_scan__mha_block_cached__dense_activation_squared_relu__decode_kernel_yw:
    s_waitcnt vmcnt(3)
    v_xor_b32 v36, v129, v235
    v_bitop3_b32 v36, v36, v131, v235 bitop3:0xf6
    v_and_b32 v129, 0xffff0000, v128
    v_lshlrev_b32 v128, 16, v128
    v_and_b32 v131, 0xffff0000, v130
    v_lshlrev_b32 v130, 16, v130
    v_mul_f32 v32, v128, v112
    v_mul_f32 v33, v129, v112
    v_mul_f32 v34, v130, v112
    v_mul_f32 v35, v131, v112
    s_waitcnt vmcnt(2)
    v_bitop3_b32 v36, v36, v133, v235 bitop3:0xf6
    v_bitop3_b32 v36, v36, v135, v235 bitop3:0xf6
    v_and_b32 v133, 0xffff0000, v132
    v_lshlrev_b32 v132, 16, v132
    v_and_b32 v135, 0xffff0000, v134
    v_lshlrev_b32 v134, 16, v134
    v_fmac_f32 v32, v132, v113
    v_fmac_f32 v33, v133, v113
    v_fmac_f32 v34, v134, v113
    v_fmac_f32 v35, v135, v113
    s_waitcnt vmcnt(1)
    v_bitop3_b32 v36, v36, v137, v235 bitop3:0xf6
    v_bitop3_b32 v36, v36, v139, v235 bitop3:0xf6
    v_and_b32 v137, 0xffff0000, v136
    v_lshlrev_b32 v136, 16, v136
    v_and_b32 v139, 0xffff0000, v138
    v_lshlrev_b32 v138, 16, v138
    v_fmac_f32 v32, v136, v114
    v_fmac_f32 v33, v137, v114
    v_fmac_f32 v34, v138, v114
    v_fmac_f32 v35, v139, v114
    s_waitcnt vmcnt(0)
    v_bitop3_b32 v36, v36, v141, v235 bitop3:0xf6
    v_bitop3_b32 v36, v36, v143, v235 bitop3:0xf6
    v_and_b32 v141, 0xffff0000, v140
    v_lshlrev_b32 v140, 16, v140
    v_and_b32 v143, 0xffff0000, v142
    v_lshlrev_b32 v142, 16, v142
    v_fmac_f32 v32, v140, v115
    v_fmac_f32 v33, v141, v115
    v_fmac_f32 v34, v142, v115
    v_fmac_f32 v35, v143, v115
    v_cmp_ne_u32 vcc, 0, v36
    s_add_u32 s56, s56, 1
    s_cmp_gt_u32 s56, 262144
    s_cbranch_vccz recurrent_scan__mha_block_cached__dense_activation_squared_relu__decode_kernel_yok
    s_cbranch_scc1 recurrent_scan__mha_block_cached__dense_activation_squared_relu__decode_kernel_yok
    global_load_dwordx4 v[128:131], v2, s[60:61] offset:0 sc1
    global_load_dwordx4 v[132:135], v2, s[60:61] offset:1024 sc1
    global_load_dwordx4 v[136:139], v2, s[60:61] offset:2048 sc1
    global_load_dwordx4 v[140:143], v2, s[60:61] offset:3072 sc1
    s_branch recurrent_scan__mha_block_cached__dense_activation_squared_relu__decode_kernel_yw
recurrent_scan__mha_block_cached__dense_activation_squared_relu__decode_kernel_yok:
    s_nop 1
    v_permlane32_swap_b32 v32, v33
    v_permlane32_swap_b32 v34, v35
    v_add_f32 v32, v32, v33
    v_add_f32 v34, v34, v35
    s_nop 1
    v_permlane16_swap_b32 v32, v34
    v_add_f32 v32, v32, v34
    s_nop 1
    v_add_f32_dpp v32, v32, v32 row_ror:4 row_mask:0xf bank_mask:0xf
    s_nop 1
    v_add_f32_dpp v32, v32, v32 row_ror:8 row_mask:0xf bank_mask:0xf
    v_cvt_pk_bf16_f32 v32, v32, v32
    v_lshlrev_b32 v32, 16, v32
    v_mul_f32 v32, v32, v248
    v_cvt_pk_bf16_f32 v32, v32, v32
    v_lshlrev_b32 v32, 16, v32
    v_add_f32 v32, v32, v246
    v_cvt_pk_bf16_f32 v32, v32, v32
    s_mov_b32 exec_lo, 0x000f000f
    s_mov_b32 exec_hi, 0x000f000f
    global_store_short v245, v32, s[36:37]
    s_mul_i32 s12, s58, 28
    s_cmp_lg_u32 s59, s12
    s_cbranch_scc1 recurrent_scan__mha_block_cached__dense_activation_squared_relu__decode_kernel_done
    v_mov_b32 v33, 64
    s_mov_b64 exec, 1
    global_atomic_add v236, v33, s[40:41] sc1
recurrent_scan__mha_block_cached__dense_activation_squared_relu__decode_kernel_done:
recurrent_scan__mha_block_cached__dense_activation_squared_relu__decode_kernel_end:
    s_endpgm
.section .rodata,"a"
.p2align 6
.amdhsa_kernel recurrent_scan__mha_block_cached__dense_activation_squared_relu__decode_kernel
  .amdhsa_next_free_vgpr 480
  .amdhsa_next_free_sgpr 102
  .amdhsa_accum_offset 256
  .amdhsa_group_segment_fixed_size 0
  .amdhsa_kernarg_size 104
  .amdhsa_user_sgpr_count 2
  .amdhsa_user_sgpr_kernarg_segment_ptr 1
  .amdhsa_system_sgpr_workgroup_id_x 1
  .amdhsa_float_denorm_mode_32 3
.end_amdhsa_kernel
```
